```python
import torch

def _softmax(x, axis=-1):
    return torch.softmax(x, dim=axis)
def _gelu(x):
    return torch.nn.functional.gelu(x, approximate="tanh")
def _silu(x):
    return torch.nn.functional.silu(x)
def _sigmoid(x):
    return torch.sigmoid(x)
def _layernorm(x, axis=-1, eps=1e-5):
    m = x.mean(dim=axis, keepdim=True)
    v = x.var(dim=axis, keepdim=True, unbiased=False)
    return (x - m) / torch.sqrt(v + eps)
def _scatter_add(tgt, idx, src, axis=0):
    return tgt.clone().index_add_(axis, idx, src)
def _segment_sum(src, seg, n):
    out = torch.zeros((n,) + src.shape[1:], dtype=src.dtype)
    return out.index_add_(0, seg, src)
def _pad(x, pw):
    flat = tuple(v for pair in reversed(pw) for v in pair)
    return torch.nn.functional.pad(x, flat)

kernel_name = 'recurrent_scan__ssm_conv_h3__dense_activation_silu__prompt'

def setup_inputs():

    _w = (lambda a: (lambda t: t.to(torch.bfloat16) if t.is_floating_point() else t)(torch.as_tensor(a)))
    def _A_setup():
        B, S, D = 1, 2048, 640
        ks = 4
        return {
            "q": _w((lambda *s: torch.randn(*s, dtype=torch.bfloat16) * 0.05)(B, S, D)),
            "k": _w((lambda *s: torch.randn(*s, dtype=torch.bfloat16) * 0.8)(B, S, D)),
            "v": _w((lambda *s: torch.randn(*s, dtype=torch.bfloat16) * 0.8)(B, S, D)),
            "shift_k": _w((lambda *s: torch.randn(*s, dtype=torch.bfloat16) * 0.8)(D, ks) * 0.5),
            "ssm_k": _w((lambda *s: torch.randn(*s, dtype=torch.bfloat16) * 0.8)(D, S) * (1.0 / S ** 0.5)),
            "ssm_D": _w((lambda *s: torch.randn(*s, dtype=torch.bfloat16) * 0.8)(D)),
        }
    _A_in = _A_setup()

    def _B_setup():
        B, S, D, F = 1, 2048, 640, 1728
        return {
            "x": _w((lambda *s: torch.randn(*s, dtype=torch.bfloat16) * 0.05)(B, S, D)),
            "w1": _w((lambda *s: torch.randn(*s, dtype=torch.bfloat16) * 0.8)(D, F) * (D ** -0.5)),
            "w2": _w((lambda *s: torch.randn(*s, dtype=torch.bfloat16) * 0.2)(F, D) * (F ** -0.5)),
        }
    _B_in = _B_setup()

    return {
        "A_q": _A_in["q"],
        "A_k": _A_in["k"],
        "A_v": _A_in["v"],
        "A_shift_k": _A_in["shift_k"],
        "A_ssm_k": _A_in["ssm_k"],
        "A_ssm_D": _A_in["ssm_D"],
        "B_x": _B_in["x"],
        "B_w1": _B_in["w1"],
        "B_w2": _B_in["w2"],
    }

def reference(A_q, A_k, A_v, A_shift_k, A_ssm_k, A_ssm_D, B_x, B_w1, B_w2):
    def _A_ref(q, k, v, shift_k, ssm_k, ssm_D):
        B, S, D = q.shape
        ks = shift_k.shape[-1]
        k_pad = _pad(k, ((0, 0), (ks - 1, 0), (0, 0)))
        k_shift = torch.zeros_like(k)
        for t in range(ks):
            k_shift = k_shift + k_pad[:, t:t + S, :] * shift_k[:, ks - 1 - t][None, None, :]
        kv = k_shift * v
        L = 2 * S
        kv_pad = _pad(kv, ((0, 0), (0, S), (0, 0)))
        kf_pad = _pad(ssm_k, ((0, 0), (0, S)))
        kv_f = (lambda x, axes=(-2,-1): torch.fft.rfft2(x.float(), dim=axes))(kv_pad[:, None, :, :], axes=(1, 2))
        kf_f = (lambda x, axes=(-2,-1): torch.fft.rfft2(x.float(), dim=axes))(kf_pad[:, None, :], axes=(1, 2))
        kf_f = (lambda x, *d: x.permute(*d))(kf_f, 1, 2, 0)
        y_f = kv_f * kf_f[None, :, :, :]
        y = (lambda x, s, axes=(-2,-1): torch.fft.irfft2(x, s=s, dim=axes).to(torch.bfloat16))(y_f, (1, L), axes=(1, 2))[:, 0, :S, :]
        y = y + kv * ssm_D[None, None, :]
        return q * y

    def _B_ref(x, w1, w2):
        h = torch.einsum("bsd,df->bsf", x, w1)
        h = _silu(h)
        out = torch.einsum("bsf,fd->bsd", h, w2)
        return out

    x = A_q
    xn = _layernorm(x, axis=-1)
    s = _A_ref(xn, A_k, A_v, A_shift_k, A_ssm_k, A_ssm_D)
    g = _silu(_B_ref(xn, B_w1, B_w2))
    return x + s * g
```

```asm
; @launch grid=(256,1,1) block=(512,1,1) lds=163840
.amdgcn_target "amdgcn-amd-amdhsa--gfx950"
.text
.globl recurrent_scan__ssm_conv_h3__dense_activation_silu__prompt_kernel
.p2align 8
.type recurrent_scan__ssm_conv_h3__dense_activation_silu__prompt_kernel,@function
recurrent_scan__ssm_conv_h3__dense_activation_silu__prompt_kernel:
    s_cmp_ge_u32 s2, 256
    s_cbranch_scc1 k1_exit
    s_load_dwordx16 s[4:19], s[0:1], 0
    s_load_dwordx8 s[20:27], s[0:1], 64
    s_mov_b32 s96, 0
    s_cmp_lt_u32 s2, 64
    s_cbranch_scc1 k1_prep
    v_and_b32 v1, 63, v0
    v_lshrrev_b32 v2, 6, v0
    s_and_b32 s68, s2, 7
    v_readfirstlane_b32 s60, v2
    s_sub_u32 s69, s2, 64
    s_lshr_b32 s69, s69, 3
    s_lshr_b32 s63, s68, 1
    s_lshl_b32 s63, s63, 2
    s_and_b32 s70, s69, 3
    s_add_u32 s63, s63, s70
    s_and_b32 s64, s68, 1
    s_mul_i32 s64, s64, 6
    s_lshr_b32 s70, s69, 2
    s_add_u32 s64, s64, s70
    s_and_b32 s65, s64, 1
    s_lshr_b32 s61, s60, 2
    s_and_b32 s62, s60, 3
    s_mul_i32 s66, s63, 163840
    s_mul_i32 s67, s64, 288
    s_mul_i32 s68, s63, 3
    s_mul_i32 s70, s64, 2
    s_add_u32 s68, s68, s70
    s_mul_i32 s70, s68, 6554
    s_lshr_b32 s70, s70, 16
    s_mul_i32 s70, s70, 10
    s_sub_u32 s68, s68, s70
    s_lshl_b32 s76, s68, 7
    s_mul_i32 s77, s68, 221184
    s_lshl_b32 s72, s60, 11
    s_lshl_b32 s73, s60, 10
    s_add_u32 s73, s73, 16384
    s_lshl_b32 s71, s60, 8
    s_add_u32 s71, s71, 32768
    v_lshrrev_b32 v2, 3, v1
    v_and_b32 v3, 7, v1
    v_xor_b32 v3, v3, v2
    s_lshl_b32 s68, s60, 4
    v_add_u32 v2, s68, v2
    v_mul_u32_u24 v8, 1280, v2
    v_lshl_add_u32 v8, v3, 4, v8

    v_add_u32 v7, 0, v0
    v_mul_u32_u24 v2, 3641, v7
    v_lshrrev_b32 v2, 16, v2
    v_mul_u32_u24 v3, 18, v2
    v_sub_u32 v3, v7, v3
    v_and_b32 v4, 0x33, v2
    v_and_b32 v5, 4, v2
    v_lshl_or_b32 v4, v5, 1, v4
    v_and_b32 v5, 8, v2
    v_lshrrev_b32 v5, 1, v5
    v_or_b32 v4, v4, v5
    v_mul_u32_u24 v4, 3456, v4
    v_lshl_add_u32 v9, v3, 4, v4

    v_add_u32 v7, 512, v0
    v_mul_u32_u24 v2, 3641, v7
    v_lshrrev_b32 v2, 16, v2
    v_mul_u32_u24 v3, 18, v2
    v_sub_u32 v3, v7, v3
    v_and_b32 v4, 0x33, v2
    v_and_b32 v5, 4, v2
    v_lshl_or_b32 v4, v5, 1, v4
    v_and_b32 v5, 8, v2
    v_lshrrev_b32 v5, 1, v5
    v_or_b32 v4, v4, v5
    v_mul_u32_u24 v4, 3456, v4
    v_lshl_add_u32 v10, v3, 4, v4

    s_lshl_b32 s68, s60, 4
    s_add_u32 s68, s68, 1024
    v_and_b32 v7, 15, v1
    v_add_u32 v7, s68, v7
    v_mul_u32_u24 v2, 3641, v7
    v_lshrrev_b32 v2, 16, v2
    v_mul_u32_u24 v3, 18, v2
    v_sub_u32 v3, v7, v3
    v_and_b32 v4, 0x33, v2
    v_and_b32 v5, 4, v2
    v_lshl_or_b32 v4, v5, 1, v4
    v_and_b32 v5, 8, v2
    v_lshrrev_b32 v5, 1, v5
    v_or_b32 v4, v4, v5
    v_mul_u32_u24 v4, 3456, v4
    v_lshl_add_u32 v11, v3, 4, v4

    s_waitcnt lgkmcnt(0)
    s_mov_b32 s28, s4
    s_and_b32 s29, s5, 0xffff
    s_mov_b32 s30, 2621440
    s_mov_b32 s31, 0x00020000
    s_mov_b32 s44, s18
    s_and_b32 s45, s19, 0xffff
    s_mov_b32 s46, 2211840
    s_mov_b32 s47, 0x00020000
    s_add_u32 s68, s67, s77
    s_add_u32 m0, s71, 0
    s_mov_b64 exec, 0xffff
    buffer_load_dwordx4 v11, s[44:47], s68 offen lds
    s_mov_b64 exec, -1
    s_add_u32 m0, s73, 0
    s_add_u32 s69, s66, s76
    buffer_load_dwordx4 v9, s[44:47], s68 offen lds
    s_add_u32 m0, s73, 8192
    s_add_u32 s70, s69, 10240
    buffer_load_dwordx4 v10, s[44:47], s68 offen lds
    s_add_u32 m0, s72, 0
    s_add_u32 s76, s76, 128
    buffer_load_dwordx4 v8, s[28:31], s69 offen lds
    s_add_u32 s77, s77, 221184
    s_cmp_ge_u32 s76, 1280
    s_cselect_b32 s76, 0, s76
    s_cselect_b32 s77, 0, s77
    s_add_u32 m0, s72, 1024
    s_nop 0
    buffer_load_dwordx4 v8, s[28:31], s70 offen lds
    s_mov_b32 s52, s26
    s_and_b32 s53, s27, 0xffff
    s_mov_b32 s54, 17825792
    s_mov_b32 s55, 0x00020000
    s_mov_b32 s56, s24
    s_and_b32 s57, s25, 0xffff
    s_mov_b32 s58, 256
    s_mov_b32 s59, 0x00020000
    v_mov_b32 v3, 0
    v_lshlrev_b32 v4, 2, v1
    v_add_u32 v4, 161536, v4
    ds_write_b32 v4, v3
    v_mov_b32 v27, 128
    v_mov_b32 v20, 192
    v_mov_b32 v26, 161540
    s_mov_b32 s89, 1
    s_waitcnt lgkmcnt(0)

    v_lshrrev_b32 v2, 2, v1
    v_and_b32 v2, 3, v2
    v_lshrrev_b32 v3, 4, v1
    v_and_b32 v4, 1, v3
    v_lshl_add_u32 v2, v4, 2, v2
    v_lshrrev_b32 v4, 1, v3
    v_lshl_add_u32 v2, v4, 4, v2
    v_mul_u32_u24 v2, 288, v2
    v_and_b32 v4, 3, v1
    v_lshl_add_u32 v2, v4, 3, v2
    s_mul_i32 s68, s61, 9216
    s_add_u32 s68, s68, 16384
    v_add_u32 v2, s68, v2

    s_add_u32 s80, s62, 0
    s_and_b32 s80, s80, 3
    s_lshl_b32 s69, s65, 5
    s_lshl_b32 s70, s80, 6
    s_add_u32 s69, s69, s70
    v_add_u32 v208, s69, v2
    v_add_u32 v209, 69632, v208

    s_add_u32 s81, s62, 1
    s_and_b32 s81, s81, 3
    s_lshl_b32 s69, s65, 5
    s_lshl_b32 s70, s81, 6
    s_add_u32 s69, s69, s70
    v_add_u32 v210, s69, v2
    v_add_u32 v211, 69632, v210

    s_add_u32 s82, s62, 2
    s_and_b32 s82, s82, 3
    s_lshl_b32 s69, s65, 5
    s_lshl_b32 s70, s82, 6
    s_add_u32 s69, s69, s70
    v_add_u32 v212, s69, v2
    v_add_u32 v213, 69632, v212

    s_add_u32 s83, s62, 3
    s_and_b32 s83, s83, 3
    s_lshl_b32 s69, s65, 5
    s_lshl_b32 s70, s83, 6
    s_add_u32 s69, s69, s70
    v_add_u32 v214, s69, v2
    v_add_u32 v215, 69632, v214

    s_lshl_b32 s69, s65, 8
    s_sub_u32 s69, 256, s69
    v_add_u32 v14, s69, v2
    v_add_u32 v15, 69632, v14
    v_and_b32 v4, 15, v1
    s_lshl_b32 s68, s61, 2
    v_add_u32 v5, s68, v3
    v_and_b32 v6, 7, v4
    v_xor_b32 v5, v5, v6
    v_lshlrev_b32 v5, 4, v5
    v_lshl_add_u32 v5, v4, 7, v5
    s_lshl_b32 s68, s62, 12
    s_lshl_b32 s69, s61, 11
    s_add_u32 s68, s68, s69
    v_add_u32 v16, s68, v5
    v_xor_b32 v18, 2048, v16
    v_add_u32 v17, 69632, v16
    v_add_u32 v19, 69632, v18

    v_mov_b32 v32, 0
    v_mov_b32 v33, 0
    v_mov_b32 v34, 0
    v_mov_b32 v35, 0
    v_mov_b32 v36, 0
    v_mov_b32 v37, 0
    v_mov_b32 v38, 0
    v_mov_b32 v39, 0
    v_mov_b32 v40, 0
    v_mov_b32 v41, 0
    v_mov_b32 v42, 0
    v_mov_b32 v43, 0
    v_mov_b32 v44, 0
    v_mov_b32 v45, 0
    v_mov_b32 v46, 0
    v_mov_b32 v47, 0
    v_mov_b32 v48, 0
    v_mov_b32 v49, 0
    v_mov_b32 v50, 0
    v_mov_b32 v51, 0
    v_mov_b32 v52, 0
    v_mov_b32 v53, 0
    v_mov_b32 v54, 0
    v_mov_b32 v55, 0
    v_mov_b32 v56, 0
    v_mov_b32 v57, 0
    v_mov_b32 v58, 0
    v_mov_b32 v59, 0
    v_mov_b32 v60, 0
    v_mov_b32 v61, 0
    v_mov_b32 v62, 0
    v_mov_b32 v63, 0
    v_mov_b32 v64, 0
    v_mov_b32 v65, 0
    v_mov_b32 v66, 0
    v_mov_b32 v67, 0
    v_mov_b32 v68, 0
    v_mov_b32 v69, 0
    v_mov_b32 v70, 0
    v_mov_b32 v71, 0
    v_mov_b32 v72, 0
    v_mov_b32 v73, 0
    v_mov_b32 v74, 0
    v_mov_b32 v75, 0
    v_mov_b32 v76, 0
    v_mov_b32 v77, 0
    v_mov_b32 v78, 0
    v_mov_b32 v79, 0
    v_mov_b32 v80, 0
    v_mov_b32 v81, 0
    v_mov_b32 v82, 0
    v_mov_b32 v83, 0
    v_mov_b32 v84, 0
    v_mov_b32 v85, 0
    v_mov_b32 v86, 0
    v_mov_b32 v87, 0
    v_mov_b32 v88, 0
    v_mov_b32 v89, 0
    v_mov_b32 v90, 0
    v_mov_b32 v91, 0
    v_mov_b32 v92, 0
    v_mov_b32 v93, 0
    v_mov_b32 v94, 0
    v_mov_b32 v95, 0
    v_mov_b32 v96, 0
    v_mov_b32 v97, 0
    v_mov_b32 v98, 0
    v_mov_b32 v99, 0
    v_mov_b32 v100, 0
    v_mov_b32 v101, 0
    v_mov_b32 v102, 0
    v_mov_b32 v103, 0
    v_mov_b32 v228, 0x3f803f80
    v_mov_b32 v229, 0x3f803f80
    v_mov_b32 v230, 0x3f803f80
    v_mov_b32 v231, 0x3f803f80
    v_mov_b32 v232, 0
    v_mov_b32 v233, 0
    v_mov_b32 v234, 0
    v_mov_b32 v235, 0
    v_mov_b32 v236, 0
    v_mov_b32 v237, 0
    v_mov_b32 v238, 0
    v_mov_b32 v239, 0
    v_mov_b32 v240, 0
    v_mov_b32 v241, 0
    v_mov_b32 v242, 0
    v_mov_b32 v243, 0
    v_mov_b32 v192, 0
    v_mov_b32 v193, 0
    v_mov_b32 v194, 0
    v_mov_b32 v195, 0
    v_mov_b32 v196, 0
    v_mov_b32 v197, 0
    v_mov_b32 v198, 0
    v_mov_b32 v199, 0
    v_mov_b32 v200, 0
    v_mov_b32 v201, 0
    v_mov_b32 v202, 0
    v_mov_b32 v203, 0
    v_mov_b32 v204, 0
    v_mov_b32 v205, 0
    v_mov_b32 v206, 0
    v_mov_b32 v207, 0
    s_barrier
    s_add_u32 s68, s67, s77
    s_add_u32 m0, s71, 34816
    s_mov_b64 exec, 0xffff
    buffer_load_dwordx4 v11, s[44:47], s68 offen lds
    s_mov_b64 exec, -1
    s_add_u32 m0, s73, 34816
    s_add_u32 s69, s66, s76
    buffer_load_dwordx4 v9, s[44:47], s68 offen lds
    s_add_u32 m0, s73, 43008
    s_add_u32 s70, s69, 10240
    buffer_load_dwordx4 v10, s[44:47], s68 offen lds
    s_add_u32 m0, s72, 34816
    s_add_u32 s76, s76, 128
    buffer_load_dwordx4 v8, s[28:31], s69 offen lds
    s_add_u32 s77, s77, 221184
    s_cmp_ge_u32 s76, 1280
    s_cselect_b32 s76, 0, s76
    s_cselect_b32 s77, 0, s77
    s_add_u32 m0, s72, 35840
    s_nop 0
    buffer_load_dwordx4 v8, s[28:31], s70 offen lds
    v_and_b32 v5, 15, v1
    v_lshrrev_b32 v6, 4, v1
    v_and_b32 v7, 3, v1
    v_cmp_eq_u32 s[34:35], 1, v7
    v_cmp_eq_u32 s[36:37], 2, v7
    v_cmp_eq_u32 s[38:39], 3, v7
    v_lshrrev_b32 v7, 2, v5
    v_cmp_eq_u32 s[40:41], v7, v6
    v_cmp_gt_u32 s[42:43], 3, v5
    v_cmp_eq_u32 s[74:75], 1, v5
    v_cmp_eq_u32 s[78:79], 2, v5
    s_lshl_b32 s68, s62, 8
    v_lshl_add_u32 v244, v5, 4, s68
    s_mul_i32 s32, s63, 10
    s_lshl_b32 s69, s64, 1
    s_add_u32 s32, s32, s69
    s_add_u32 s32, s32, s61
    s_lshl_b32 s32, s32, 10
    s_add_u32 s32, s32, 17301504
    s_cmp_lt_u32 s64, 5
    s_cselect_b32 s32, s32, 2130706432
    s_cselect_b32 s50, 1, 0
    s_mul_i32 s33, s64, 10
    s_add_u32 s33, s33, s63
    s_add_u32 s33, s33, s61
    s_mul_i32 s33, s33, 576
    s_add_u32 s33, s33, 17498112
    s_cmp_lt_u32 s63, 10
    s_cselect_b32 s33, s33, 2130706432
    s_bitcmp1_b32 s63, 0
    s_cselect_b32 s33, 2130706432, s33
    s_cmp_lg_u32 s33, 2130706432
    s_cselect_b32 s51, 2, 0
    s_or_b32 s50, s50, s51
    s_mov_b32 s51, 0
    v_lshlrev_b32 v247, 4, v6
    s_lshl_b32 s70, s62, 7
    v_add_u32 v246, s70, v247
    v_add_u32 v245, 64, v246
    v_add_u32 v247, 512, v247
    v_cndmask_b32 v246, v246, v245, s[74:75]
    v_cndmask_b32 v246, v246, v247, s[78:79]
    s_lshl_b32 s68, s63, 8
    s_add_u32 s68, s68, 16887808
    s_lshl_b32 s69, s64, 8
    s_add_u32 s69, s69, 16887936
    v_mov_b32 v224, s68
    v_writelane_b32 v224, s69, 1
    v_mov_b32 v225, 1
    v_mov_b32 v226, 161564
    s_mul_i32 s68, s63, 10240
    s_add_u32 s68, s68, 17301504
    s_mul_i32 s69, s64, 5760
    s_add_u32 s69, s69, 17496064
    v_lshlrev_b32 v2, 4, v0
    v_add_u32 v248, s68, v2
    v_add_u32 v4, 8192, v248
    v_add_u32 v5, s69, v2
    v_cmp_gt_u32 vcc, 128, v0
    v_add_u32 v251, 86016, v2
    s_nop 0
    v_cndmask_b32 v249, v5, v4, vcc

    s_mov_b32 s88, 0
    s_sub_u32 s90, s2, 64
    s_lshl_b32 s90, s90, 1
    s_mov_b32 s91, 1
    v_and_b32 v250, 63, v0
    v_lshlrev_b32 v250, 4, v250
    s_and_b32 s68, s60, 1
    s_lshl_b32 s68, s68, 11
    s_lshr_b32 s69, s60, 2
    s_lshl_b32 s48, s69, 10
    s_add_u32 s68, s68, s48
    v_add_u32 v250, s68, v250
    s_and_b32 s48, s60, 3
    s_mul_i32 s48, s48, 6144
    s_mul_i32 s69, s69, 3072
    s_add_u32 s48, s48, s69
    s_lshr_b32 s68, s60, 1
    s_and_b32 s68, s68, 1
    s_add_u32 s68, s68, s90

    s_lshl_b32 s69, s68, 12
    s_add_u32 s84, s12, s69
    s_addc_u32 s85, s13, 0
    s_and_b32 s85, s85, 0xffff
    s_mov_b32 s86, 4096
    s_mov_b32 s87, 0x00020000

    s_waitcnt vmcnt(5)
    s_barrier
    ds_read_b128 v[176:179], v16 offset:0
    ds_read_b128 v[180:183], v18 offset:0
    ds_read_b64_tr_b16 v[104:105], v208 offset:0
    ds_read_b64_tr_b16 v[106:107], v208 offset:2304
    ds_read_b64_tr_b16 v[108:109], v208 offset:32
    ds_read_b64_tr_b16 v[110:111], v208 offset:2336
    ds_read_b64_tr_b16 v[112:113], v210 offset:0
    ds_read_b64_tr_b16 v[114:115], v210 offset:2304
    ds_read_b64_tr_b16 v[116:117], v210 offset:32
    ds_read_b64_tr_b16 v[118:119], v210 offset:2336
    ds_read_b64_tr_b16 v[120:121], v212 offset:0
    ds_read_b64_tr_b16 v[122:123], v212 offset:2304
    ds_read_b64_tr_b16 v[124:125], v212 offset:32
    ds_read_b64_tr_b16 v[126:127], v212 offset:2336
    ds_read_b64_tr_b16 v[128:129], v214 offset:0
    ds_read_b64_tr_b16 v[130:131], v214 offset:2304
    ds_read_b64_tr_b16 v[132:133], v214 offset:32
    ds_read_b64_tr_b16 v[134:135], v214 offset:2336
    ds_read_b64_tr_b16 v[136:137], v14 offset:0
    ds_read_b64_tr_b16 v[138:139], v14 offset:2304
    s_waitcnt lgkmcnt(0)
    v_mfma_f32_16x16x32_bf16 v[32:35], v[104:107], v[176:179], v[32:35]
    v_mfma_f32_16x16x32_bf16 v[36:39], v[104:107], v[180:183], v[36:39]
    v_mfma_f32_16x16x32_bf16 v[40:43], v[108:111], v[176:179], v[40:43]
    v_mfma_f32_16x16x32_bf16 v[192:195], v[228:231], v[176:179], v[192:195]
    v_mfma_f32_16x16x32_bf16 v[44:47], v[108:111], v[180:183], v[44:47]
    v_mfma_f32_16x16x32_bf16 v[48:51], v[112:115], v[176:179], v[48:51]
    v_mfma_f32_16x16x32_bf16 v[52:55], v[112:115], v[180:183], v[52:55]
    v_mfma_f32_16x16x32_bf16 v[196:199], v[176:179], v[176:179], v[196:199]
    v_mfma_f32_16x16x32_bf16 v[56:59], v[116:119], v[176:179], v[56:59]
    v_mfma_f32_16x16x32_bf16 v[60:63], v[116:119], v[180:183], v[60:63]
    s_add_u32 s68, s67, s77
    s_add_u32 m0, s71, 69632
    s_mov_b64 exec, 0xffff
    buffer_load_dwordx4 v11, s[44:47], s68 offen lds
    s_mov_b64 exec, -1
    s_add_u32 m0, s73, 69632
    s_add_u32 s69, s66, s76
    buffer_load_dwordx4 v9, s[44:47], s68 offen lds
    s_add_u32 m0, s73, 77824
    s_add_u32 s70, s69, 10240
    buffer_load_dwordx4 v10, s[44:47], s68 offen lds
    s_add_u32 m0, s72, 69632
    s_add_u32 s76, s76, 128
    buffer_load_dwordx4 v8, s[28:31], s69 offen lds
    s_add_u32 s77, s77, 221184
    s_cmp_ge_u32 s76, 1280
    s_cselect_b32 s76, 0, s76
    s_cselect_b32 s77, 0, s77
    s_add_u32 m0, s72, 70656
    s_nop 0
    buffer_load_dwordx4 v8, s[28:31], s70 offen lds
    s_waitcnt vmcnt(5)
    s_barrier
    ds_read_b128 v[184:187], v16 offset:34816
    ds_read_b128 v[188:191], v18 offset:34816
    v_mfma_f32_16x16x32_bf16 v[200:203], v[228:231], v[180:183], v[200:203]
    ds_read_b64_tr_b16 v[140:141], v208 offset:34816
    ds_read_b64_tr_b16 v[142:143], v208 offset:37120
    v_mfma_f32_16x16x32_bf16 v[64:67], v[120:123], v[176:179], v[64:67]
    ds_read_b64_tr_b16 v[144:145], v208 offset:34848
    ds_read_b64_tr_b16 v[146:147], v208 offset:37152
    v_mfma_f32_16x16x32_bf16 v[68:71], v[120:123], v[180:183], v[68:71]
    s_add_u32 s68, s67, s77
    s_add_u32 m0, s71, 104448
    s_mov_b64 exec, 0xffff
    buffer_load_dwordx4 v11, s[44:47], s68 offen lds
    s_mov_b64 exec, -1
    ds_read_b64_tr_b16 v[148:149], v210 offset:34816
    ds_read_b64_tr_b16 v[150:151], v210 offset:37120
    v_mfma_f32_16x16x32_bf16 v[72:75], v[124:127], v[176:179], v[72:75]
    ds_read_b64_tr_b16 v[152:153], v210 offset:34848
    ds_read_b64_tr_b16 v[154:155], v210 offset:37152
    v_mfma_f32_16x16x32_bf16 v[204:207], v[180:183], v[180:183], v[204:207]
    ds_read_b64_tr_b16 v[156:157], v212 offset:34816
    ds_read_b64_tr_b16 v[158:159], v212 offset:37120
    v_mfma_f32_16x16x32_bf16 v[76:79], v[124:127], v[180:183], v[76:79]
    s_add_u32 m0, s73, 104448
    s_add_u32 s69, s66, s76
    buffer_load_dwordx4 v9, s[44:47], s68 offen lds
    ds_read_b64_tr_b16 v[160:161], v212 offset:34848
    ds_read_b64_tr_b16 v[162:163], v212 offset:37152
    v_mfma_f32_16x16x32_bf16 v[80:83], v[128:131], v[176:179], v[80:83]
    ds_read_b64_tr_b16 v[164:165], v214 offset:34816
    ds_read_b64_tr_b16 v[166:167], v214 offset:37120
    v_mfma_f32_16x16x32_bf16 v[232:235], v[104:107], v[228:231], v[232:235]
    ds_read_b64_tr_b16 v[168:169], v214 offset:34848
    ds_read_b64_tr_b16 v[170:171], v214 offset:37152
    v_mfma_f32_16x16x32_bf16 v[84:87], v[128:131], v[180:183], v[84:87]
    s_add_u32 m0, s73, 112640
    s_add_u32 s70, s69, 10240
    buffer_load_dwordx4 v10, s[44:47], s68 offen lds
    ds_read_b64_tr_b16 v[172:173], v14 offset:34816
    ds_read_b64_tr_b16 v[174:175], v14 offset:37120
    v_mfma_f32_16x16x32_bf16 v[88:91], v[132:135], v[176:179], v[88:91]
    v_mfma_f32_16x16x32_bf16 v[92:95], v[132:135], v[180:183], v[92:95]
    v_mfma_f32_16x16x32_bf16 v[236:239], v[108:111], v[228:231], v[236:239]
    s_add_u32 m0, s72, 104448
    s_add_u32 s76, s76, 128
    buffer_load_dwordx4 v8, s[28:31], s69 offen lds
    s_add_u32 s77, s77, 221184
    s_cmp_ge_u32 s76, 1280
    s_cselect_b32 s76, 0, s76
    s_cselect_b32 s77, 0, s77
    v_mfma_f32_16x16x32_bf16 v[96:99], v[136:139], v[176:179], v[96:99]
    v_mfma_f32_16x16x32_bf16 v[100:103], v[136:139], v[180:183], v[100:103]
    v_mfma_f32_16x16x32_bf16 v[240:243], v[136:139], v[228:231], v[240:243]
    s_add_u32 m0, s72, 105472
    s_nop 0
    buffer_load_dwordx4 v8, s[28:31], s70 offen lds
    s_waitcnt lgkmcnt(0)
    v_mfma_f32_16x16x32_bf16 v[32:35], v[140:143], v[184:187], v[32:35]
    v_mfma_f32_16x16x32_bf16 v[36:39], v[140:143], v[188:191], v[36:39]
    v_mfma_f32_16x16x32_bf16 v[40:43], v[144:147], v[184:187], v[40:43]
    v_mfma_f32_16x16x32_bf16 v[192:195], v[228:231], v[184:187], v[192:195]
    v_mfma_f32_16x16x32_bf16 v[44:47], v[144:147], v[188:191], v[44:47]
    v_mfma_f32_16x16x32_bf16 v[48:51], v[148:151], v[184:187], v[48:51]
    v_mfma_f32_16x16x32_bf16 v[52:55], v[148:151], v[188:191], v[52:55]
    v_mfma_f32_16x16x32_bf16 v[196:199], v[184:187], v[184:187], v[196:199]
    v_mfma_f32_16x16x32_bf16 v[56:59], v[152:155], v[184:187], v[56:59]
    v_mfma_f32_16x16x32_bf16 v[60:63], v[152:155], v[188:191], v[60:63]
    s_waitcnt vmcnt(5)
    s_barrier
    s_cmp_lg_u32 s60, 7
    s_cbranch_scc1 g7_1
    buffer_load_dword v21, v20, s[56:59], 0 offen sc1
g7_1:
    ds_read_b128 v[176:179], v17 offset:0
    ds_read_b128 v[180:183], v19 offset:0
    v_mfma_f32_16x16x32_bf16 v[200:203], v[228:231], v[188:191], v[200:203]
    ds_read_b64_tr_b16 v[104:105], v209 offset:0
    ds_read_b64_tr_b16 v[106:107], v209 offset:2304
    v_mfma_f32_16x16x32_bf16 v[64:67], v[156:159], v[184:187], v[64:67]
    ds_read_b64_tr_b16 v[108:109], v209 offset:32
    ds_read_b64_tr_b16 v[110:111], v209 offset:2336
    v_mfma_f32_16x16x32_bf16 v[68:71], v[156:159], v[188:191], v[68:71]
    s_add_u32 s68, s67, s77
    s_add_u32 m0, s71, 0
    s_mov_b64 exec, 0xffff
    buffer_load_dwordx4 v11, s[44:47], s68 offen lds
    s_mov_b64 exec, -1
    ds_read_b64_tr_b16 v[112:113], v211 offset:0
    ds_read_b64_tr_b16 v[114:115], v211 offset:2304
    v_mfma_f32_16x16x32_bf16 v[72:75], v[160:163], v[184:187], v[72:75]
    ds_read_b64_tr_b16 v[116:117], v211 offset:32
    ds_read_b64_tr_b16 v[118:119], v211 offset:2336
    v_mfma_f32_16x16x32_bf16 v[204:207], v[188:191], v[188:191], v[204:207]
    ds_read_b64_tr_b16 v[120:121], v213 offset:0
    ds_read_b64_tr_b16 v[122:123], v213 offset:2304
    v_mfma_f32_16x16x32_bf16 v[76:79], v[160:163], v[188:191], v[76:79]
    s_add_u32 m0, s73, 0
    s_add_u32 s69, s66, s76
    buffer_load_dwordx4 v9, s[44:47], s68 offen lds
    ds_read_b64_tr_b16 v[124:125], v213 offset:32
    ds_read_b64_tr_b16 v[126:127], v213 offset:2336
    v_mfma_f32_16x16x32_bf16 v[80:83], v[164:167], v[184:187], v[80:83]
    ds_read_b64_tr_b16 v[128:129], v215 offset:0
    ds_read_b64_tr_b16 v[130:131], v215 offset:2304
    v_mfma_f32_16x16x32_bf16 v[232:235], v[140:143], v[228:231], v[232:235]
    ds_read_b64_tr_b16 v[132:133], v215 offset:32
    ds_read_b64_tr_b16 v[134:135], v215 offset:2336
    v_mfma_f32_16x16x32_bf16 v[84:87], v[164:167], v[188:191], v[84:87]
    s_add_u32 m0, s73, 8192
    s_add_u32 s70, s69, 10240
    buffer_load_dwordx4 v10, s[44:47], s68 offen lds
    ds_read_b64_tr_b16 v[136:137], v15 offset:0
    ds_read_b64_tr_b16 v[138:139], v15 offset:2304
    v_mfma_f32_16x16x32_bf16 v[88:91], v[168:171], v[184:187], v[88:91]
    v_mfma_f32_16x16x32_bf16 v[92:95], v[168:171], v[188:191], v[92:95]
    v_mfma_f32_16x16x32_bf16 v[236:239], v[144:147], v[228:231], v[236:239]
    s_add_u32 m0, s72, 0
    s_add_u32 s76, s76, 128
    buffer_load_dwordx4 v8, s[28:31], s69 offen lds
    s_add_u32 s77, s77, 221184
    s_cmp_ge_u32 s76, 1280
    s_cselect_b32 s76, 0, s76
    s_cselect_b32 s77, 0, s77
    v_mfma_f32_16x16x32_bf16 v[96:99], v[172:175], v[184:187], v[96:99]
    v_mfma_f32_16x16x32_bf16 v[100:103], v[172:175], v[188:191], v[100:103]
    v_mfma_f32_16x16x32_bf16 v[240:243], v[172:175], v[228:231], v[240:243]
    s_add_u32 m0, s72, 1024
    s_nop 0
    buffer_load_dwordx4 v8, s[28:31], s70 offen lds
    s_waitcnt lgkmcnt(0)
    v_mfma_f32_16x16x32_bf16 v[32:35], v[104:107], v[176:179], v[32:35]
    v_mfma_f32_16x16x32_bf16 v[36:39], v[104:107], v[180:183], v[36:39]
    v_mfma_f32_16x16x32_bf16 v[40:43], v[108:111], v[176:179], v[40:43]
    v_mov_b32 v28, v192
    v_mov_b32 v30, v200
    v_cndmask_b32 v29, v196, v197, s[34:35]
    v_mfma_f32_16x16x32_bf16 v[44:47], v[108:111], v[180:183], v[44:47]
    v_cndmask_b32 v31, v204, v205, s[34:35]
    v_cndmask_b32 v29, v29, v198, s[36:37]
    v_cndmask_b32 v31, v31, v206, s[36:37]
    v_mfma_f32_16x16x32_bf16 v[48:51], v[112:115], v[176:179], v[48:51]
    v_cndmask_b32 v29, v29, v199, s[38:39]
    v_cndmask_b32 v31, v31, v207, s[38:39]
    v_cndmask_b32 v232, v232, v236, s[74:75]
    v_mfma_f32_16x16x32_bf16 v[52:55], v[112:115], v[180:183], v[52:55]
    v_cndmask_b32 v233, v233, v237, s[74:75]
    v_cndmask_b32 v234, v234, v238, s[74:75]
    v_cndmask_b32 v235, v235, v239, s[74:75]
    v_cndmask_b32 v232, v232, v240, s[78:79]
    v_cndmask_b32 v233, v233, v241, s[78:79]
    v_cndmask_b32 v234, v234, v242, s[78:79]
    v_cndmask_b32 v235, v235, v243, s[78:79]
    s_waitcnt vmcnt(5)
    s_barrier
    ds_read_b128 v[184:187], v17 offset:34816
    ds_read_b128 v[188:191], v19 offset:34816
    v_mfma_f32_16x16x32_bf16 v[56:59], v[116:119], v[176:179], v[56:59]
    ds_read_b64_tr_b16 v[140:141], v209 offset:34816
    ds_read_b64_tr_b16 v[142:143], v209 offset:37120
    v_mfma_f32_16x16x32_bf16 v[60:63], v[116:119], v[180:183], v[60:63]
    ds_read_b64_tr_b16 v[144:145], v209 offset:34848
    ds_read_b64_tr_b16 v[146:147], v209 offset:37152
    v_mfma_f32_16x16x32_bf16 v[64:67], v[120:123], v[176:179], v[64:67]
    s_add_u32 s68, s67, s77
    s_add_u32 m0, s71, 34816
    s_mov_b64 exec, 0xffff
    buffer_load_dwordx4 v11, s[44:47], s68 offen lds
    s_mov_b64 exec, -1
    ds_read_b64_tr_b16 v[148:149], v211 offset:34816
    ds_read_b64_tr_b16 v[150:151], v211 offset:37120
    v_mfma_f32_16x16x32_bf16 v[68:71], v[120:123], v[180:183], v[68:71]
    ds_read_b64_tr_b16 v[152:153], v211 offset:34848
    ds_read_b64_tr_b16 v[154:155], v211 offset:37152
    v_mfma_f32_16x16x32_bf16 v[72:75], v[124:127], v[176:179], v[72:75]
    ds_read_b64_tr_b16 v[156:157], v213 offset:34816
    ds_read_b64_tr_b16 v[158:159], v213 offset:37120
    v_mfma_f32_16x16x32_bf16 v[76:79], v[124:127], v[180:183], v[76:79]
    s_add_u32 m0, s73, 34816
    s_add_u32 s69, s66, s76
    buffer_load_dwordx4 v9, s[44:47], s68 offen lds
    ds_read_b64_tr_b16 v[160:161], v213 offset:34848
    ds_read_b64_tr_b16 v[162:163], v213 offset:37152
    v_mfma_f32_16x16x32_bf16 v[80:83], v[128:131], v[176:179], v[80:83]
    ds_read_b64_tr_b16 v[164:165], v215 offset:34816
    ds_read_b64_tr_b16 v[166:167], v215 offset:37120
    v_mfma_f32_16x16x32_bf16 v[84:87], v[128:131], v[180:183], v[84:87]
    ds_read_b64_tr_b16 v[168:169], v215 offset:34848
    ds_read_b64_tr_b16 v[170:171], v215 offset:37152
    v_mfma_f32_16x16x32_bf16 v[88:91], v[132:135], v[176:179], v[88:91]
    s_add_u32 m0, s73, 43008
    s_add_u32 s70, s69, 10240
    buffer_load_dwordx4 v10, s[44:47], s68 offen lds
    ds_read_b64_tr_b16 v[172:173], v15 offset:34816
    ds_read_b64_tr_b16 v[174:175], v15 offset:37120
    v_mfma_f32_16x16x32_bf16 v[92:95], v[132:135], v[180:183], v[92:95]
    v_mfma_f32_16x16x32_bf16 v[96:99], v[136:139], v[176:179], v[96:99]
    v_mfma_f32_16x16x32_bf16 v[100:103], v[136:139], v[180:183], v[100:103]
    s_add_u32 m0, s72, 34816
    s_add_u32 s76, s76, 128
    buffer_load_dwordx4 v8, s[28:31], s69 offen lds
    s_add_u32 s77, s77, 221184
    s_cmp_ge_u32 s76, 1280
    s_cselect_b32 s76, 0, s76
    s_cselect_b32 s77, 0, s77
    s_add_u32 m0, s72, 35840
    s_nop 0
    buffer_load_dwordx4 v8, s[28:31], s70 offen lds
    s_mov_b64 exec, s[40:41]
    buffer_store_dwordx4 v[28:31], v244, s[52:55], s32 offen sc0 sc1
    s_mov_b64 exec, s[42:43]
    buffer_store_dwordx4 v[232:235], v246, s[52:55], s33 offen sc0 sc1
    s_mov_b64 exec, -1
    s_waitcnt lgkmcnt(0)
    v_mfma_f32_16x16x32_bf16 v[32:35], v[140:143], v[184:187], v[32:35]
    v_mfma_f32_16x16x32_bf16 v[36:39], v[140:143], v[188:191], v[36:39]
    v_mfma_f32_16x16x32_bf16 v[40:43], v[144:147], v[184:187], v[40:43]
    v_mfma_f32_16x16x32_bf16 v[44:47], v[144:147], v[188:191], v[44:47]
    v_mfma_f32_16x16x32_bf16 v[48:51], v[148:151], v[184:187], v[48:51]
    v_mfma_f32_16x16x32_bf16 v[52:55], v[148:151], v[188:191], v[52:55]
    s_waitcnt vmcnt(7)
    s_barrier
    ds_read_b128 v[176:179], v16 offset:0
    ds_read_b128 v[180:183], v18 offset:0
    v_mfma_f32_16x16x32_bf16 v[56:59], v[152:155], v[184:187], v[56:59]
    ds_read_b64_tr_b16 v[104:105], v208 offset:0
    ds_read_b64_tr_b16 v[106:107], v208 offset:2304
    v_mfma_f32_16x16x32_bf16 v[60:63], v[152:155], v[188:191], v[60:63]
    ds_read_b64_tr_b16 v[108:109], v208 offset:32
    ds_read_b64_tr_b16 v[110:111], v208 offset:2336
    v_mfma_f32_16x16x32_bf16 v[64:67], v[156:159], v[184:187], v[64:67]
    s_add_u32 s68, s67, s77
    s_add_u32 m0, s71, 69632
    s_mov_b64 exec, 0xffff
    buffer_load_dwordx4 v11, s[44:47], s68 offen lds
    s_mov_b64 exec, -1
    ds_read_b64_tr_b16 v[112:113], v210 offset:0
    ds_read_b64_tr_b16 v[114:115], v210 offset:2304
    v_mfma_f32_16x16x32_bf16 v[68:71], v[156:159], v[188:191], v[68:71]
    ds_read_b64_tr_b16 v[116:117], v210 offset:32
    ds_read_b64_tr_b16 v[118:119], v210 offset:2336
    v_mfma_f32_16x16x32_bf16 v[72:75], v[160:163], v[184:187], v[72:75]
    ds_read_b64_tr_b16 v[120:121], v212 offset:0
    ds_read_b64_tr_b16 v[122:123], v212 offset:2304
    v_mfma_f32_16x16x32_bf16 v[76:79], v[160:163], v[188:191], v[76:79]
    s_add_u32 m0, s73, 69632
    s_add_u32 s69, s66, s76
    buffer_load_dwordx4 v9, s[44:47], s68 offen lds
    ds_read_b64_tr_b16 v[124:125], v212 offset:32
    ds_read_b64_tr_b16 v[126:127], v212 offset:2336
    v_mfma_f32_16x16x32_bf16 v[80:83], v[164:167], v[184:187], v[80:83]
    ds_read_b64_tr_b16 v[128:129], v214 offset:0
    ds_read_b64_tr_b16 v[130:131], v214 offset:2304
    v_mfma_f32_16x16x32_bf16 v[84:87], v[164:167], v[188:191], v[84:87]
    ds_read_b64_tr_b16 v[132:133], v214 offset:32
    ds_read_b64_tr_b16 v[134:135], v214 offset:2336
    v_mfma_f32_16x16x32_bf16 v[88:91], v[168:171], v[184:187], v[88:91]
    s_add_u32 m0, s73, 77824
    s_add_u32 s70, s69, 10240
    buffer_load_dwordx4 v10, s[44:47], s68 offen lds
    ds_read_b64_tr_b16 v[136:137], v14 offset:0
    ds_read_b64_tr_b16 v[138:139], v14 offset:2304
    v_mfma_f32_16x16x32_bf16 v[92:95], v[168:171], v[188:191], v[92:95]
    v_mfma_f32_16x16x32_bf16 v[96:99], v[172:175], v[184:187], v[96:99]
    v_mfma_f32_16x16x32_bf16 v[100:103], v[172:175], v[188:191], v[100:103]
    s_add_u32 m0, s72, 69632
    s_add_u32 s76, s76, 128
    buffer_load_dwordx4 v8, s[28:31], s69 offen lds
    s_add_u32 s77, s77, 221184
    s_cmp_ge_u32 s76, 1280
    s_cselect_b32 s76, 0, s76
    s_cselect_b32 s77, 0, s77
    s_add_u32 m0, s72, 70656
    s_nop 0
    buffer_load_dwordx4 v8, s[28:31], s70 offen lds
    s_waitcnt lgkmcnt(0)
    v_mfma_f32_16x16x32_bf16 v[32:35], v[104:107], v[176:179], v[32:35]
    v_mfma_f32_16x16x32_bf16 v[36:39], v[104:107], v[180:183], v[36:39]
    v_mfma_f32_16x16x32_bf16 v[40:43], v[108:111], v[176:179], v[40:43]
    v_mfma_f32_16x16x32_bf16 v[44:47], v[108:111], v[180:183], v[44:47]
    v_mfma_f32_16x16x32_bf16 v[48:51], v[112:115], v[176:179], v[48:51]
    v_mfma_f32_16x16x32_bf16 v[52:55], v[112:115], v[180:183], v[52:55]
    s_waitcnt vmcnt(7)
    s_barrier
    ds_read_b128 v[184:187], v16 offset:34816
    ds_read_b128 v[188:191], v18 offset:34816
    v_mfma_f32_16x16x32_bf16 v[56:59], v[116:119], v[176:179], v[56:59]
    ds_read_b64_tr_b16 v[140:141], v208 offset:34816
    ds_read_b64_tr_b16 v[142:143], v208 offset:37120
    v_mfma_f32_16x16x32_bf16 v[60:63], v[116:119], v[180:183], v[60:63]
    ds_read_b64_tr_b16 v[144:145], v208 offset:34848
    ds_read_b64_tr_b16 v[146:147], v208 offset:37152
    v_mfma_f32_16x16x32_bf16 v[64:67], v[120:123], v[176:179], v[64:67]
    s_add_u32 s68, s67, s77
    s_add_u32 m0, s71, 104448
    s_mov_b64 exec, 0xffff
    buffer_load_dwordx4 v11, s[44:47], s68 offen lds
    s_mov_b64 exec, -1
    ds_read_b64_tr_b16 v[148:149], v210 offset:34816
    ds_read_b64_tr_b16 v[150:151], v210 offset:37120
    v_mfma_f32_16x16x32_bf16 v[68:71], v[120:123], v[180:183], v[68:71]
    ds_read_b64_tr_b16 v[152:153], v210 offset:34848
    ds_read_b64_tr_b16 v[154:155], v210 offset:37152
    v_mfma_f32_16x16x32_bf16 v[72:75], v[124:127], v[176:179], v[72:75]
    ds_read_b64_tr_b16 v[156:157], v212 offset:34816
    ds_read_b64_tr_b16 v[158:159], v212 offset:37120
    v_mfma_f32_16x16x32_bf16 v[76:79], v[124:127], v[180:183], v[76:79]
    s_add_u32 m0, s73, 104448
    s_add_u32 s69, s66, s76
    buffer_load_dwordx4 v9, s[44:47], s68 offen lds
    ds_read_b64_tr_b16 v[160:161], v212 offset:34848
    ds_read_b64_tr_b16 v[162:163], v212 offset:37152
    v_mfma_f32_16x16x32_bf16 v[80:83], v[128:131], v[176:179], v[80:83]
    ds_read_b64_tr_b16 v[164:165], v214 offset:34816
    ds_read_b64_tr_b16 v[166:167], v214 offset:37120
    v_mfma_f32_16x16x32_bf16 v[84:87], v[128:131], v[180:183], v[84:87]
    ds_read_b64_tr_b16 v[168:169], v214 offset:34848
    ds_read_b64_tr_b16 v[170:171], v214 offset:37152
    v_mfma_f32_16x16x32_bf16 v[88:91], v[132:135], v[176:179], v[88:91]
    s_add_u32 m0, s73, 112640
    s_add_u32 s70, s69, 10240
    buffer_load_dwordx4 v10, s[44:47], s68 offen lds
    ds_read_b64_tr_b16 v[172:173], v14 offset:34816
    ds_read_b64_tr_b16 v[174:175], v14 offset:37120
    v_mfma_f32_16x16x32_bf16 v[92:95], v[132:135], v[180:183], v[92:95]
    v_mfma_f32_16x16x32_bf16 v[96:99], v[136:139], v[176:179], v[96:99]
    v_mfma_f32_16x16x32_bf16 v[100:103], v[136:139], v[180:183], v[100:103]
    s_add_u32 m0, s72, 104448
    s_add_u32 s76, s76, 128
    buffer_load_dwordx4 v8, s[28:31], s69 offen lds
    s_add_u32 s77, s77, 221184
    s_cmp_ge_u32 s76, 1280
    s_cselect_b32 s76, 0, s76
    s_cselect_b32 s77, 0, s77
    s_add_u32 m0, s72, 105472
    s_nop 0
    buffer_load_dwordx4 v8, s[28:31], s70 offen lds
    s_waitcnt lgkmcnt(0)
    v_mfma_f32_16x16x32_bf16 v[32:35], v[140:143], v[184:187], v[32:35]
    v_mfma_f32_16x16x32_bf16 v[36:39], v[140:143], v[188:191], v[36:39]
    v_mfma_f32_16x16x32_bf16 v[40:43], v[144:147], v[184:187], v[40:43]
    v_mfma_f32_16x16x32_bf16 v[44:47], v[144:147], v[188:191], v[44:47]
    v_mfma_f32_16x16x32_bf16 v[48:51], v[148:151], v[184:187], v[48:51]
    v_mfma_f32_16x16x32_bf16 v[52:55], v[148:151], v[188:191], v[52:55]
    s_waitcnt vmcnt(5)
    s_barrier
    s_cmp_lg_u32 s60, 7
    s_cbranch_scc1 g7_2
    v_readfirstlane_b32 s68, v21
    s_cmp_lg_u32 s68, 0
    s_cbranch_scc1 g7z_3

    v_mov_b32 v20, 192
pg_4:
    buffer_load_dword v21, v20, s[56:59], 0 offen sc1
    s_waitcnt vmcnt(0)
    v_readfirstlane_b32 s68, v21
    s_cmp_lg_u32 s68, 0
    s_cbranch_scc1 pgd_5
    s_sleep 8
    s_add_u32 s96, s96, 1
    s_cmp_lt_u32 s96, 0x400000
    s_cbranch_scc1 pg_4

pgd_5:
g7z_3:
    ds_write_b32 v226, v225
    s_cmp_eq_u32 s50, 0
    s_cbranch_scc1 g7_2
    s_mov_b64 exec, s[50:51]
    buffer_atomic_add v225, v224, s[52:55], 0 offen sc1
    s_mov_b64 exec, -1

g7_2:
    ds_read_b128 v[176:179], v17 offset:0
    ds_read_b128 v[180:183], v19 offset:0
    v_mfma_f32_16x16x32_bf16 v[56:59], v[152:155], v[184:187], v[56:59]
    ds_read_b64_tr_b16 v[104:105], v209 offset:0
    ds_read_b64_tr_b16 v[106:107], v209 offset:2304
    v_mfma_f32_16x16x32_bf16 v[60:63], v[152:155], v[188:191], v[60:63]
    ds_read_b64_tr_b16 v[108:109], v209 offset:32
    ds_read_b64_tr_b16 v[110:111], v209 offset:2336
    v_mfma_f32_16x16x32_bf16 v[64:67], v[156:159], v[184:187], v[64:67]
    s_add_u32 s68, s67, s77
    s_add_u32 m0, s71, 0
    s_mov_b64 exec, 0xffff
    buffer_load_dwordx4 v11, s[44:47], s68 offen lds
    s_mov_b64 exec, -1
    ds_read_b64_tr_b16 v[112:113], v211 offset:0
    ds_read_b64_tr_b16 v[114:115], v211 offset:2304
    v_mfma_f32_16x16x32_bf16 v[68:71], v[156:159], v[188:191], v[68:71]
    ds_read_b64_tr_b16 v[116:117], v211 offset:32
    ds_read_b64_tr_b16 v[118:119], v211 offset:2336
    v_mfma_f32_16x16x32_bf16 v[72:75], v[160:163], v[184:187], v[72:75]
    ds_read_b64_tr_b16 v[120:121], v213 offset:0
    ds_read_b64_tr_b16 v[122:123], v213 offset:2304
    v_mfma_f32_16x16x32_bf16 v[76:79], v[160:163], v[188:191], v[76:79]
    s_add_u32 m0, s73, 0
    s_add_u32 s69, s66, s76
    buffer_load_dwordx4 v9, s[44:47], s68 offen lds
    ds_read_b64_tr_b16 v[124:125], v213 offset:32
    ds_read_b64_tr_b16 v[126:127], v213 offset:2336
    v_mfma_f32_16x16x32_bf16 v[80:83], v[164:167], v[184:187], v[80:83]
    ds_read_b64_tr_b16 v[128:129], v215 offset:0
    ds_read_b64_tr_b16 v[130:131], v215 offset:2304
    v_mfma_f32_16x16x32_bf16 v[84:87], v[164:167], v[188:191], v[84:87]
    ds_read_b64_tr_b16 v[132:133], v215 offset:32
    ds_read_b64_tr_b16 v[134:135], v215 offset:2336
    v_mfma_f32_16x16x32_bf16 v[88:91], v[168:171], v[184:187], v[88:91]
    s_add_u32 m0, s73, 8192
    s_add_u32 s70, s69, 10240
    buffer_load_dwordx4 v10, s[44:47], s68 offen lds
    ds_read_b64_tr_b16 v[136:137], v15 offset:0
    ds_read_b64_tr_b16 v[138:139], v15 offset:2304
    v_mfma_f32_16x16x32_bf16 v[92:95], v[168:171], v[188:191], v[92:95]
    v_mfma_f32_16x16x32_bf16 v[96:99], v[172:175], v[184:187], v[96:99]
    v_mfma_f32_16x16x32_bf16 v[100:103], v[172:175], v[188:191], v[100:103]
    s_add_u32 m0, s72, 0
    s_add_u32 s76, s76, 128
    buffer_load_dwordx4 v8, s[28:31], s69 offen lds
    s_add_u32 s77, s77, 221184
    s_cmp_ge_u32 s76, 1280
    s_cselect_b32 s76, 0, s76
    s_cselect_b32 s77, 0, s77
    s_add_u32 m0, s72, 1024
    s_nop 0
    buffer_load_dwordx4 v8, s[28:31], s70 offen lds
    s_waitcnt lgkmcnt(0)
    v_mfma_f32_16x16x32_bf16 v[32:35], v[104:107], v[176:179], v[32:35]
    v_mfma_f32_16x16x32_bf16 v[36:39], v[104:107], v[180:183], v[36:39]
    v_mfma_f32_16x16x32_bf16 v[40:43], v[108:111], v[176:179], v[40:43]
    v_mfma_f32_16x16x32_bf16 v[44:47], v[108:111], v[180:183], v[44:47]
    v_mfma_f32_16x16x32_bf16 v[48:51], v[112:115], v[176:179], v[48:51]
    v_mfma_f32_16x16x32_bf16 v[52:55], v[112:115], v[180:183], v[52:55]
    s_waitcnt vmcnt(5)
    s_barrier
    ds_read_b128 v[184:187], v17 offset:34816
    ds_read_b128 v[188:191], v19 offset:34816
    v_mfma_f32_16x16x32_bf16 v[56:59], v[116:119], v[176:179], v[56:59]
    ds_read_b64_tr_b16 v[140:141], v209 offset:34816
    ds_read_b64_tr_b16 v[142:143], v209 offset:37120
    v_mfma_f32_16x16x32_bf16 v[60:63], v[116:119], v[180:183], v[60:63]
    ds_read_b64_tr_b16 v[144:145], v209 offset:34848
    ds_read_b64_tr_b16 v[146:147], v209 offset:37152
    v_mfma_f32_16x16x32_bf16 v[64:67], v[120:123], v[176:179], v[64:67]
    s_add_u32 s68, s67, s77
    s_add_u32 m0, s71, 34816
    s_mov_b64 exec, 0xffff
    buffer_load_dwordx4 v11, s[44:47], s68 offen lds
    s_mov_b64 exec, -1
    ds_read_b64_tr_b16 v[148:149], v211 offset:34816
    ds_read_b64_tr_b16 v[150:151], v211 offset:37120
    v_mfma_f32_16x16x32_bf16 v[68:71], v[120:123], v[180:183], v[68:71]
    ds_read_b64_tr_b16 v[152:153], v211 offset:34848
    ds_read_b64_tr_b16 v[154:155], v211 offset:37152
    v_mfma_f32_16x16x32_bf16 v[72:75], v[124:127], v[176:179], v[72:75]
    ds_read_b64_tr_b16 v[156:157], v213 offset:34816
    ds_read_b64_tr_b16 v[158:159], v213 offset:37120
    v_mfma_f32_16x16x32_bf16 v[76:79], v[124:127], v[180:183], v[76:79]
    s_add_u32 m0, s73, 34816
    s_add_u32 s69, s66, s76
    buffer_load_dwordx4 v9, s[44:47], s68 offen lds
    ds_read_b64_tr_b16 v[160:161], v213 offset:34848
    ds_read_b64_tr_b16 v[162:163], v213 offset:37152
    v_mfma_f32_16x16x32_bf16 v[80:83], v[128:131], v[176:179], v[80:83]
    ds_read_b64_tr_b16 v[164:165], v215 offset:34816
    ds_read_b64_tr_b16 v[166:167], v215 offset:37120
    v_mfma_f32_16x16x32_bf16 v[84:87], v[128:131], v[180:183], v[84:87]
    ds_read_b64_tr_b16 v[168:169], v215 offset:34848
    ds_read_b64_tr_b16 v[170:171], v215 offset:37152
    v_mfma_f32_16x16x32_bf16 v[88:91], v[132:135], v[176:179], v[88:91]
    s_add_u32 m0, s73, 43008
    s_add_u32 s70, s69, 10240
    buffer_load_dwordx4 v10, s[44:47], s68 offen lds
    ds_read_b64_tr_b16 v[172:173], v15 offset:34816
    ds_read_b64_tr_b16 v[174:175], v15 offset:37120
    v_mfma_f32_16x16x32_bf16 v[92:95], v[132:135], v[180:183], v[92:95]
    v_mfma_f32_16x16x32_bf16 v[96:99], v[136:139], v[176:179], v[96:99]
    v_mfma_f32_16x16x32_bf16 v[100:103], v[136:139], v[180:183], v[100:103]
    s_add_u32 m0, s72, 34816
    s_add_u32 s76, s76, 128
    buffer_load_dwordx4 v8, s[28:31], s69 offen lds
    s_add_u32 s77, s77, 221184
    s_cmp_ge_u32 s76, 1280
    s_cselect_b32 s76, 0, s76
    s_cselect_b32 s77, 0, s77
    s_add_u32 m0, s72, 35840
    s_nop 0
    buffer_load_dwordx4 v8, s[28:31], s70 offen lds
    s_waitcnt lgkmcnt(0)
    v_mfma_f32_16x16x32_bf16 v[32:35], v[140:143], v[184:187], v[32:35]
    v_mfma_f32_16x16x32_bf16 v[36:39], v[140:143], v[188:191], v[36:39]
    v_mfma_f32_16x16x32_bf16 v[40:43], v[144:147], v[184:187], v[40:43]
    v_mfma_f32_16x16x32_bf16 v[44:47], v[144:147], v[188:191], v[44:47]
    v_mfma_f32_16x16x32_bf16 v[48:51], v[148:151], v[184:187], v[48:51]
    v_mfma_f32_16x16x32_bf16 v[52:55], v[148:151], v[188:191], v[52:55]
    s_waitcnt vmcnt(5)
    s_barrier
    s_cmp_lg_u32 s60, 7
    s_cbranch_scc1 g7_6
    s_mov_b64 exec, 3
    buffer_load_dword v21, v224, s[52:55], 0 offen sc1
    s_mov_b64 exec, -1

g7_6:
    ds_read_b128 v[176:179], v16 offset:0
    ds_read_b128 v[180:183], v18 offset:0
    v_mfma_f32_16x16x32_bf16 v[56:59], v[152:155], v[184:187], v[56:59]
    ds_read_b64_tr_b16 v[104:105], v208 offset:0
    ds_read_b64_tr_b16 v[106:107], v208 offset:2304
    v_mfma_f32_16x16x32_bf16 v[60:63], v[152:155], v[188:191], v[60:63]
    ds_read_b64_tr_b16 v[108:109], v208 offset:32
    ds_read_b64_tr_b16 v[110:111], v208 offset:2336
    v_mfma_f32_16x16x32_bf16 v[64:67], v[156:159], v[184:187], v[64:67]
    ds_read_b64_tr_b16 v[112:113], v210 offset:0
    ds_read_b64_tr_b16 v[114:115], v210 offset:2304
    v_mfma_f32_16x16x32_bf16 v[68:71], v[156:159], v[188:191], v[68:71]
    ds_read_b64_tr_b16 v[116:117], v210 offset:32
    ds_read_b64_tr_b16 v[118:119], v210 offset:2336
    v_mfma_f32_16x16x32_bf16 v[72:75], v[160:163], v[184:187], v[72:75]
    ds_read_b64_tr_b16 v[120:121], v212 offset:0
    ds_read_b64_tr_b16 v[122:123], v212 offset:2304
    v_mfma_f32_16x16x32_bf16 v[76:79], v[160:163], v[188:191], v[76:79]
    ds_read_b64_tr_b16 v[124:125], v212 offset:32
    ds_read_b64_tr_b16 v[126:127], v212 offset:2336
    v_mfma_f32_16x16x32_bf16 v[80:83], v[164:167], v[184:187], v[80:83]
    ds_read_b64_tr_b16 v[128:129], v214 offset:0
    ds_read_b64_tr_b16 v[130:131], v214 offset:2304
    v_mfma_f32_16x16x32_bf16 v[84:87], v[164:167], v[188:191], v[84:87]
    ds_read_b64_tr_b16 v[132:133], v214 offset:32
    ds_read_b64_tr_b16 v[134:135], v214 offset:2336
    v_mfma_f32_16x16x32_bf16 v[88:91], v[168:171], v[184:187], v[88:91]
    ds_read_b64_tr_b16 v[136:137], v14 offset:0
    ds_read_b64_tr_b16 v[138:139], v14 offset:2304
    v_mfma_f32_16x16x32_bf16 v[92:95], v[168:171], v[188:191], v[92:95]
    v_mfma_f32_16x16x32_bf16 v[96:99], v[172:175], v[184:187], v[96:99]
    v_mfma_f32_16x16x32_bf16 v[100:103], v[172:175], v[188:191], v[100:103]
    s_waitcnt lgkmcnt(0)
    v_mfma_f32_16x16x32_bf16 v[32:35], v[104:107], v[176:179], v[32:35]
    v_mfma_f32_16x16x32_bf16 v[36:39], v[104:107], v[180:183], v[36:39]
    v_mfma_f32_16x16x32_bf16 v[40:43], v[108:111], v[176:179], v[40:43]
    v_mfma_f32_16x16x32_bf16 v[44:47], v[108:111], v[180:183], v[44:47]
    v_mfma_f32_16x16x32_bf16 v[48:51], v[112:115], v[176:179], v[48:51]
    v_mfma_f32_16x16x32_bf16 v[52:55], v[112:115], v[180:183], v[52:55]
    s_waitcnt vmcnt(0)
    s_cmp_lg_u32 s60, 7
    s_cbranch_scc1 g7_7
g7p_8:
    v_readlane_b32 s68, v21, 0
    v_readlane_b32 s69, v21, 1
    s_min_u32 s68, s68, s69
    s_cmp_ge_u32 s68, 5
    s_cbranch_scc1 g7_7
    s_sleep 2
    s_mov_b64 exec, 3
    buffer_load_dword v21, v224, s[52:55], 0 offen sc1
    s_mov_b64 exec, -1
    s_waitcnt vmcnt(0)
    s_add_u32 s96, s96, 1
    s_cmp_lt_u32 s96, 0x400000
    s_cbranch_scc1 g7p_8

g7_7:
    s_barrier
    buffer_load_dwordx4 v[216:219], v248, s[52:55], 0 offen sc1
    buffer_load_dwordx4 v[220:223], v249, s[52:55], 0 offen sc1
    ds_read_b128 v[184:187], v16 offset:34816
    ds_read_b128 v[188:191], v18 offset:34816
    v_mfma_f32_16x16x32_bf16 v[56:59], v[116:119], v[176:179], v[56:59]
    ds_read_b64_tr_b16 v[140:141], v208 offset:34816
    ds_read_b64_tr_b16 v[142:143], v208 offset:37120
    v_mfma_f32_16x16x32_bf16 v[60:63], v[116:119], v[180:183], v[60:63]
    ds_read_b64_tr_b16 v[144:145], v208 offset:34848
    ds_read_b64_tr_b16 v[146:147], v208 offset:37152
    v_mfma_f32_16x16x32_bf16 v[64:67], v[120:123], v[176:179], v[64:67]
    s_add_u32 m0, s48, 128512
    s_mov_b32 s68, 0
    buffer_load_dwordx4 v250, s[84:87], s68 offen lds
    ds_read_b64_tr_b16 v[148:149], v210 offset:34816
    ds_read_b64_tr_b16 v[150:151], v210 offset:37120
    v_mfma_f32_16x16x32_bf16 v[68:71], v[120:123], v[180:183], v[68:71]
    ds_read_b64_tr_b16 v[152:153], v210 offset:34848
    ds_read_b64_tr_b16 v[154:155], v210 offset:37152
    v_mfma_f32_16x16x32_bf16 v[72:75], v[124:127], v[176:179], v[72:75]
    ds_read_b64_tr_b16 v[156:157], v212 offset:34816
    ds_read_b64_tr_b16 v[158:159], v212 offset:37120
    v_mfma_f32_16x16x32_bf16 v[76:79], v[124:127], v[180:183], v[76:79]
    s_add_u32 m0, s48, 129536
    s_mov_b32 s68, 4
    buffer_load_dwordx4 v250, s[84:87], s68 offen lds
    ds_read_b64_tr_b16 v[160:161], v212 offset:34848
    ds_read_b64_tr_b16 v[162:163], v212 offset:37152
    v_mfma_f32_16x16x32_bf16 v[80:83], v[128:131], v[176:179], v[80:83]
    ds_read_b64_tr_b16 v[164:165], v214 offset:34816
    ds_read_b64_tr_b16 v[166:167], v214 offset:37120
    v_mfma_f32_16x16x32_bf16 v[84:87], v[128:131], v[180:183], v[84:87]
    ds_read_b64_tr_b16 v[168:169], v214 offset:34848
    ds_read_b64_tr_b16 v[170:171], v214 offset:37152
    v_mfma_f32_16x16x32_bf16 v[88:91], v[132:135], v[176:179], v[88:91]
    s_add_u32 m0, s48, 130560
    s_mov_b32 s68, 8
    buffer_load_dwordx4 v250, s[84:87], s68 offen lds
    ds_read_b64_tr_b16 v[172:173], v14 offset:34816
    ds_read_b64_tr_b16 v[174:175], v14 offset:37120
    v_mfma_f32_16x16x32_bf16 v[92:95], v[132:135], v[180:183], v[92:95]
    v_mfma_f32_16x16x32_bf16 v[96:99], v[136:139], v[176:179], v[96:99]
    v_mfma_f32_16x16x32_bf16 v[100:103], v[136:139], v[180:183], v[100:103]
    s_waitcnt lgkmcnt(0)
    v_mfma_f32_16x16x32_bf16 v[32:35], v[140:143], v[184:187], v[32:35]
    v_mfma_f32_16x16x32_bf16 v[36:39], v[140:143], v[188:191], v[36:39]
    v_mfma_f32_16x16x32_bf16 v[40:43], v[144:147], v[184:187], v[40:43]
    v_mfma_f32_16x16x32_bf16 v[44:47], v[144:147], v[188:191], v[44:47]
    v_mfma_f32_16x16x32_bf16 v[48:51], v[148:151], v[184:187], v[48:51]
    v_mfma_f32_16x16x32_bf16 v[52:55], v[148:151], v[188:191], v[52:55]
    v_mfma_f32_16x16x32_bf16 v[56:59], v[152:155], v[184:187], v[56:59]
    v_mfma_f32_16x16x32_bf16 v[60:63], v[152:155], v[188:191], v[60:63]
    v_mfma_f32_16x16x32_bf16 v[64:67], v[156:159], v[184:187], v[64:67]
    v_mfma_f32_16x16x32_bf16 v[68:71], v[156:159], v[188:191], v[68:71]
    v_mfma_f32_16x16x32_bf16 v[72:75], v[160:163], v[184:187], v[72:75]
    v_mfma_f32_16x16x32_bf16 v[76:79], v[160:163], v[188:191], v[76:79]
    v_mfma_f32_16x16x32_bf16 v[80:83], v[164:167], v[184:187], v[80:83]
    v_mfma_f32_16x16x32_bf16 v[84:87], v[164:167], v[188:191], v[84:87]
    v_mfma_f32_16x16x32_bf16 v[88:91], v[168:171], v[184:187], v[88:91]
    v_mfma_f32_16x16x32_bf16 v[92:95], v[168:171], v[188:191], v[92:95]
    v_mfma_f32_16x16x32_bf16 v[96:99], v[172:175], v[184:187], v[96:99]
    v_mfma_f32_16x16x32_bf16 v[100:103], v[172:175], v[188:191], v[100:103]
    s_waitcnt vmcnt(3)
    ds_write_b128 v251, v[216:219]
    ds_write_b128 v251, v[220:223] offset:8192
    s_waitcnt lgkmcnt(0)

    s_barrier
    s_cmp_ge_u32 s60, 5
    s_cbranch_scc1 erd_10
    s_cmp_ge_u32 s60, 2
    s_cbranch_scc1 ecs_9
    v_lshrrev_b32 v8, 5, v0
    v_and_b32 v9, 15, v0
    v_lshl_add_u32 v8, v8, 4, v9
    v_lshlrev_b32 v8, 4, v8
    v_lshrrev_b32 v9, 1, v0
    v_and_b32 v9, 8, v9
    v_add_u32 v8, v8, v9
    v_add_u32 v8, 86016, v8
    v_xor_b32 v9, 8, v8

    ds_read_b64 v[192:193], v8 offset:0
    ds_read_b64 v[194:195], v9 offset:1024
    ds_read_b64 v[196:197], v8 offset:2048
    ds_read_b64 v[198:199], v9 offset:3072
    ds_read_b64 v[200:201], v8 offset:4096
    ds_read_b64 v[202:203], v9 offset:5120
    ds_read_b64 v[204:205], v8 offset:6144
    ds_read_b64 v[206:207], v9 offset:7168
    ds_read_b64 v[208:209], v8 offset:8192
    ds_read_b64 v[210:211], v9 offset:9216
    s_branch erd_10
ecs_9:
    v_subrev_u32 v8, 128, v0
    v_min_u32 v8, 143, v8
    v_lshlrev_b32 v8, 2, v8
    v_add_u32 v9, 96256, v8

    ds_read_b32 v192, v9 offset:0
    ds_read_b32 v194, v9 offset:576
    ds_read_b32 v196, v9 offset:1152
    ds_read_b32 v198, v9 offset:1728
    ds_read_b32 v200, v9 offset:2304
    ds_read_b32 v202, v9 offset:2880
    ds_read_b32 v204, v9 offset:3456
    ds_read_b32 v206, v9 offset:4032
    ds_read_b32 v208, v9 offset:4608
    ds_read_b32 v210, v9 offset:5184
erd_10:
    s_mul_i32 s68, s60, 9216
    v_lshlrev_b32 v2, 4, v1
    v_add_u32 v3, s68, v2
    s_xor_b32 s69, s60, 4
    s_mul_i32 s69, s69, 9216
    v_add_u32 v4, s69, v2
    v_and_b32 v5, 15, v1
    v_lshrrev_b32 v6, 4, v1
    v_lshlrev_b32 v10, 4, v6

    ds_write_b128 v3, v[36:39] offset:0
    ds_write_b128 v3, v[44:47] offset:1024
    ds_write_b128 v3, v[52:55] offset:2048
    ds_write_b128 v3, v[60:63] offset:3072
    ds_write_b128 v3, v[68:71] offset:4096
    ds_write_b128 v3, v[76:79] offset:5120
    ds_write_b128 v3, v[84:87] offset:6144
    ds_write_b128 v3, v[92:95] offset:7168
    ds_write_b128 v3, v[100:103] offset:8192
    s_cmp_ge_u32 s60, 5
    s_cbranch_scc1 frd_12
    s_waitcnt lgkmcnt(9)

    v_pk_add_f32 v[192:193], v[192:193], v[208:209]
    v_pk_add_f32 v[194:195], v[194:195], v[210:211]
    v_pk_add_f32 v[192:193], v[192:193], v[200:201]
    v_pk_add_f32 v[194:195], v[194:195], v[202:203]
    v_pk_add_f32 v[196:197], v[196:197], v[204:205]
    v_pk_add_f32 v[198:199], v[198:199], v[206:207]
    v_pk_add_f32 v[192:193], v[192:193], v[196:197]
    v_pk_add_f32 v[194:195], v[194:195], v[198:199]
    v_pk_add_f32 v[192:193], v[192:193], v[194:195]
    s_cmp_ge_u32 s60, 2
    s_cbranch_scc1 fcs_11
    v_mul_f32 v192, 0x3acccccd, v192
    v_mul_f32 v193, 0x3acccccd, v193
    v_fma_f32 v193, -v192, v192, v193
    v_max_f32 v193, 0, v193

    v_cvt_pk_bf16_f32 v200, v192, v192
    v_lshlrev_b32 v200, 16, v200
    v_cvt_pk_bf16_f32 v193, v193, v193
    v_lshlrev_b32 v193, 16, v193
    v_add_f32 v193, 0x3727c5ac, v193
    v_cvt_pk_bf16_f32 v193, v193, v193
    v_lshlrev_b32 v193, 16, v193
    v_sqrt_f32 v193, v193
    s_nop 0
    v_cvt_pk_bf16_f32 v198, v193, v193
    v_lshlrev_b32 v198, 16, v198
    v_rcp_f32 v201, v198
    v_sub_f32 v196, 0, v200
    v_lshlrev_b32 v8, 4, v0
    v_mul_f32 v197, 0xbfb8aa3b, v201
    v_add_u32 v8, 73728, v8
    ds_write_b128 v8, v[196:199]
    s_cmp_lg_u32 s64, 0
    s_cbranch_scc1 frd_12
    s_lshl_b32 s69, s63, 10
    s_add_u32 s69, s69, 16777216
    v_lshlrev_b32 v8, 3, v0
    buffer_store_dwordx2 v[200:201], v8, s[52:55], s69 offen sc0 sc1
    s_branch frd_12

fcs_11:
    v_add_u32 v8, 81920, v8
    ds_write_b32 v8, v192

frd_12:
    v_add_u32 v10, 81920, v10
    s_lshl_b32 s70, s80, 7
    v_add_u32 v12, s70, v10
    s_lshl_b32 s70, s81, 7
    v_add_u32 v13, s70, v10
    s_lshl_b32 s70, s82, 7
    v_add_u32 v14, s70, v10
    s_lshl_b32 s70, s83, 7
    v_add_u32 v15, s70, v10
    s_lshl_b32 s80, s80, 12
    s_lshl_b32 s81, s81, 12
    s_lshl_b32 s82, s82, 12
    s_lshl_b32 s83, s83, 12
    s_lshl_b32 s68, s62, 9
    s_lshl_b32 s69, s61, 8
    s_add_u32 s68, s68, s69
    s_add_u32 s68, s68, 73728
    v_lshl_add_u32 v8, v5, 4, s68
    s_lshl_b32 s68, s63, 3
    s_lshl_b32 s69, s62, 1
    s_add_u32 s68, s68, s69
    s_add_u32 s68, s68, s61
    s_and_b32 s70, s68, 3
    s_lshr_b32 s68, s68, 2
    s_mul_i32 s68, s68, 54
    s_mul_i32 s69, s64, 9
    s_add_u32 s69, s69, s65
    s_lshr_b32 s69, s69, 1
    s_add_u32 s68, s68, s69
    s_lshl_b32 s68, s68, 2
    s_add_u32 s68, s68, s70
    s_lshl_b32 s68, s68, 10
    v_and_b32 v7, 1, v6
    v_lshrrev_b32 v6, 1, v6
    v_lshl_add_u32 v24, v7, 1, v6
    v_lshl_add_u32 v24, v24, 4, v5
    v_lshlrev_b32 v24, 4, v24
    v_add_u32 v24, s68, v24
    v_lshl_add_u32 v25, v6, 4, v5
    v_lshlrev_b32 v25, 4, v25
    v_lshl_add_u32 v25, v7, 3, v25
    s_mul_i32 s69, s65, 4294947328
    s_add_u32 s69, s69, 16384
    s_add_u32 s68, s68, s69
    v_add_u32 v25, s68, v25
    s_waitcnt lgkmcnt(0)
    s_barrier

    s_cmp_lg_u32 s60, 7
    s_cbranch_scc1 g7_14
    buffer_load_dword v175, v27, s[56:59], 0 offen sc1
    s_and_b32 s68, s2, 15
    s_lshl_b32 s68, s68, 8
    s_add_u32 s68, s68, 16883712
    v_mov_b32 v173, s68
    v_mov_b32 v172, 0
    v_mov_b32 v174, 0

g7_14:
    ds_read_b128 v[176:179], v8
    ds_read_b128 v[104:107], v4 offset:0
    ds_read_b128 v[192:195], v12 offset:0
    ds_read_b128 v[108:111], v4 offset:1024
    ds_read_b128 v[196:199], v12 offset:64
    ds_read_b128 v[112:115], v4 offset:2048
    ds_read_b128 v[200:203], v13 offset:0
    ds_read_b128 v[116:119], v4 offset:3072
    ds_read_b128 v[204:207], v13 offset:64
    ds_read_b128 v[120:123], v4 offset:4096
    ds_read_b128 v[208:211], v14 offset:0
    s_waitcnt lgkmcnt(10)
    v_mov_b32 v16, v176
    v_mov_b32 v17, v176
    v_mov_b32 v18, v177
    v_mov_b32 v19, v177
    v_mov_b32 v20, v178
    v_mov_b32 v21, v178

    s_waitcnt lgkmcnt(8)
    v_pk_add_f32 v[32:33], v[32:33], v[104:105]
    v_pk_add_f32 v[34:35], v[34:35], v[106:107]
    ds_read_b128 v[124:127], v4 offset:5120
    ds_read_b128 v[212:215], v14 offset:64
    v_pk_fma_f32 v[32:33], v[16:17], v[192:193], v[32:33]
    v_pk_fma_f32 v[34:35], v[16:17], v[194:195], v[34:35]
    v_pk_mul_f32 v[36:37], v[32:33], v[18:19]
    v_pk_mul_f32 v[38:39], v[34:35], v[18:19]
    v_exp_f32 v36, v36
    v_exp_f32 v37, v37
    v_exp_f32 v38, v38
    v_exp_f32 v39, v39
    s_nop 0
    v_pk_fma_f32 v[36:37], v[36:37], v[20:21], v[20:21]
    v_pk_fma_f32 v[38:39], v[38:39], v[20:21], v[20:21]
    v_rcp_f32 v36, v36
    v_rcp_f32 v37, v37
    v_rcp_f32 v38, v38
    v_rcp_f32 v39, v39
    s_nop 0
    v_pk_mul_f32 v[32:33], v[32:33], v[36:37]
    v_pk_mul_f32 v[34:35], v[34:35], v[38:39]
    v_cvt_pk_bf16_f32 v140, v32, v33
    v_cvt_pk_bf16_f32 v141, v34, v35
    s_waitcnt lgkmcnt(8)
    v_pk_add_f32 v[40:41], v[40:41], v[108:109]
    v_pk_add_f32 v[42:43], v[42:43], v[110:111]
    ds_read_b128 v[128:131], v4 offset:6144
    ds_read_b128 v[216:219], v15 offset:0
    v_pk_fma_f32 v[40:41], v[16:17], v[196:197], v[40:41]
    v_pk_fma_f32 v[42:43], v[16:17], v[198:199], v[42:43]
    v_pk_mul_f32 v[44:45], v[40:41], v[18:19]
    v_pk_mul_f32 v[46:47], v[42:43], v[18:19]
    v_exp_f32 v44, v44
    v_exp_f32 v45, v45
    v_exp_f32 v46, v46
    v_exp_f32 v47, v47
    s_nop 0
    v_pk_fma_f32 v[44:45], v[44:45], v[20:21], v[20:21]
    v_pk_fma_f32 v[46:47], v[46:47], v[20:21], v[20:21]
    v_rcp_f32 v44, v44
    v_rcp_f32 v45, v45
    v_rcp_f32 v46, v46
    v_rcp_f32 v47, v47
    s_nop 0
    v_pk_mul_f32 v[40:41], v[40:41], v[44:45]
    v_pk_mul_f32 v[42:43], v[42:43], v[46:47]
    v_cvt_pk_bf16_f32 v142, v40, v41
    v_cvt_pk_bf16_f32 v143, v42, v43
    s_nop 1
    v_permlane16_swap_b32 v140, v142
    v_permlane16_swap_b32 v141, v143
    s_nop 1
    buffer_store_dwordx4 v[140:143], v24, s[52:55], s80 offen sc0 sc1
    s_waitcnt lgkmcnt(8)
    v_pk_add_f32 v[48:49], v[48:49], v[112:113]
    v_pk_add_f32 v[50:51], v[50:51], v[114:115]
    ds_read_b128 v[132:135], v4 offset:7168
    ds_read_b128 v[220:223], v15 offset:64
    v_pk_fma_f32 v[48:49], v[16:17], v[200:201], v[48:49]
    v_pk_fma_f32 v[50:51], v[16:17], v[202:203], v[50:51]
    v_pk_mul_f32 v[52:53], v[48:49], v[18:19]
    v_pk_mul_f32 v[54:55], v[50:51], v[18:19]
    v_exp_f32 v52, v52
    v_exp_f32 v53, v53
    v_exp_f32 v54, v54
    v_exp_f32 v55, v55
    s_nop 0
    v_pk_fma_f32 v[52:53], v[52:53], v[20:21], v[20:21]
    v_pk_fma_f32 v[54:55], v[54:55], v[20:21], v[20:21]
    v_rcp_f32 v52, v52
    v_rcp_f32 v53, v53
    v_rcp_f32 v54, v54
    v_rcp_f32 v55, v55
    s_nop 0
    v_pk_mul_f32 v[48:49], v[48:49], v[52:53]
    v_pk_mul_f32 v[50:51], v[50:51], v[54:55]
    v_cvt_pk_bf16_f32 v144, v48, v49
    v_cvt_pk_bf16_f32 v145, v50, v51
    s_waitcnt lgkmcnt(8)
    v_pk_add_f32 v[56:57], v[56:57], v[116:117]
    v_pk_add_f32 v[58:59], v[58:59], v[118:119]
    ds_read_b128 v[136:139], v4 offset:8192
    ds_read_b128 v[224:227], v10 offset:512
    v_pk_fma_f32 v[56:57], v[16:17], v[204:205], v[56:57]
    v_pk_fma_f32 v[58:59], v[16:17], v[206:207], v[58:59]
    v_pk_mul_f32 v[60:61], v[56:57], v[18:19]
    v_pk_mul_f32 v[62:63], v[58:59], v[18:19]
    v_exp_f32 v60, v60
    v_exp_f32 v61, v61
    v_exp_f32 v62, v62
    v_exp_f32 v63, v63
    s_nop 0
    v_pk_fma_f32 v[60:61], v[60:61], v[20:21], v[20:21]
    v_pk_fma_f32 v[62:63], v[62:63], v[20:21], v[20:21]
    v_rcp_f32 v60, v60
    v_rcp_f32 v61, v61
    v_rcp_f32 v62, v62
    v_rcp_f32 v63, v63
    s_nop 0
    v_pk_mul_f32 v[56:57], v[56:57], v[60:61]
    v_pk_mul_f32 v[58:59], v[58:59], v[62:63]
    v_cvt_pk_bf16_f32 v146, v56, v57
    v_cvt_pk_bf16_f32 v147, v58, v59
    s_nop 1
    v_permlane16_swap_b32 v144, v146
    v_permlane16_swap_b32 v145, v147
    s_nop 1
    buffer_store_dwordx4 v[144:147], v24, s[52:55], s81 offen sc0 sc1
    s_waitcnt lgkmcnt(8)
    v_pk_add_f32 v[64:65], v[64:65], v[120:121]
    v_pk_add_f32 v[66:67], v[66:67], v[122:123]
    v_pk_fma_f32 v[64:65], v[16:17], v[208:209], v[64:65]
    v_pk_fma_f32 v[66:67], v[16:17], v[210:211], v[66:67]
    v_pk_mul_f32 v[68:69], v[64:65], v[18:19]
    v_pk_mul_f32 v[70:71], v[66:67], v[18:19]
    v_exp_f32 v68, v68
    v_exp_f32 v69, v69
    v_exp_f32 v70, v70
    v_exp_f32 v71, v71
    s_nop 0
    v_pk_fma_f32 v[68:69], v[68:69], v[20:21], v[20:21]
    v_pk_fma_f32 v[70:71], v[70:71], v[20:21], v[20:21]
    v_rcp_f32 v68, v68
    v_rcp_f32 v69, v69
    v_rcp_f32 v70, v70
    v_rcp_f32 v71, v71
    s_nop 0
    v_pk_mul_f32 v[64:65], v[64:65], v[68:69]
    v_pk_mul_f32 v[66:67], v[66:67], v[70:71]
    v_cvt_pk_bf16_f32 v148, v64, v65
    v_cvt_pk_bf16_f32 v149, v66, v67
    s_waitcnt lgkmcnt(6)
    v_pk_add_f32 v[72:73], v[72:73], v[124:125]
    v_pk_add_f32 v[74:75], v[74:75], v[126:127]
    v_pk_fma_f32 v[72:73], v[16:17], v[212:213], v[72:73]
    v_pk_fma_f32 v[74:75], v[16:17], v[214:215], v[74:75]
    v_pk_mul_f32 v[76:77], v[72:73], v[18:19]
    v_pk_mul_f32 v[78:79], v[74:75], v[18:19]
    v_exp_f32 v76, v76
    v_exp_f32 v77, v77
    v_exp_f32 v78, v78
    v_exp_f32 v79, v79
    s_nop 0
    v_pk_fma_f32 v[76:77], v[76:77], v[20:21], v[20:21]
    v_pk_fma_f32 v[78:79], v[78:79], v[20:21], v[20:21]
    v_rcp_f32 v76, v76
    v_rcp_f32 v77, v77
    v_rcp_f32 v78, v78
    v_rcp_f32 v79, v79
    s_nop 0
    v_pk_mul_f32 v[72:73], v[72:73], v[76:77]
    v_pk_mul_f32 v[74:75], v[74:75], v[78:79]
    v_cvt_pk_bf16_f32 v150, v72, v73
    v_cvt_pk_bf16_f32 v151, v74, v75
    s_nop 1
    v_permlane16_swap_b32 v148, v150
    v_permlane16_swap_b32 v149, v151
    s_nop 1
    buffer_store_dwordx4 v[148:151], v24, s[52:55], s82 offen sc0 sc1
    s_cmp_lg_u32 s60, 7
    s_cbranch_scc1 g7_15
    s_waitcnt vmcnt(3)
    ds_write_b32 v26, v175
    v_cmp_eq_u32 vcc, 1, v174
    v_cmp_ne_u32 s[74:75], 0, v172
    v_mov_b32 v173, 161536
    s_and_b64 vcc, vcc, s[74:75]
    v_cndmask_b32 v174, 0, 1, vcc
    ds_max_u32 v173, v174

    s_waitcnt lgkmcnt(0)
g7_15:
    s_waitcnt lgkmcnt(4)
    v_pk_add_f32 v[80:81], v[80:81], v[128:129]
    v_pk_add_f32 v[82:83], v[82:83], v[130:131]
    v_pk_fma_f32 v[80:81], v[16:17], v[216:217], v[80:81]
    v_pk_fma_f32 v[82:83], v[16:17], v[218:219], v[82:83]
    v_pk_mul_f32 v[84:85], v[80:81], v[18:19]
    v_pk_mul_f32 v[86:87], v[82:83], v[18:19]
    v_exp_f32 v84, v84
    v_exp_f32 v85, v85
    v_exp_f32 v86, v86
    v_exp_f32 v87, v87
    s_nop 0
    v_pk_fma_f32 v[84:85], v[84:85], v[20:21], v[20:21]
    v_pk_fma_f32 v[86:87], v[86:87], v[20:21], v[20:21]
    v_rcp_f32 v84, v84
    v_rcp_f32 v85, v85
    v_rcp_f32 v86, v86
    v_rcp_f32 v87, v87
    s_nop 0
    v_pk_mul_f32 v[80:81], v[80:81], v[84:85]
    v_pk_mul_f32 v[82:83], v[82:83], v[86:87]
    v_cvt_pk_bf16_f32 v152, v80, v81
    v_cvt_pk_bf16_f32 v153, v82, v83
    s_waitcnt lgkmcnt(2)
    v_pk_add_f32 v[88:89], v[88:89], v[132:133]
    v_pk_add_f32 v[90:91], v[90:91], v[134:135]
    v_pk_fma_f32 v[88:89], v[16:17], v[220:221], v[88:89]
    v_pk_fma_f32 v[90:91], v[16:17], v[222:223], v[90:91]
    v_pk_mul_f32 v[92:93], v[88:89], v[18:19]
    v_pk_mul_f32 v[94:95], v[90:91], v[18:19]
    v_exp_f32 v92, v92
    v_exp_f32 v93, v93
    v_exp_f32 v94, v94
    v_exp_f32 v95, v95
    s_nop 0
    v_pk_fma_f32 v[92:93], v[92:93], v[20:21], v[20:21]
    v_pk_fma_f32 v[94:95], v[94:95], v[20:21], v[20:21]
    v_rcp_f32 v92, v92
    v_rcp_f32 v93, v93
    v_rcp_f32 v94, v94
    v_rcp_f32 v95, v95
    s_nop 0
    v_pk_mul_f32 v[88:89], v[88:89], v[92:93]
    v_pk_mul_f32 v[90:91], v[90:91], v[94:95]
    v_cvt_pk_bf16_f32 v154, v88, v89
    v_cvt_pk_bf16_f32 v155, v90, v91
    s_nop 1
    v_permlane16_swap_b32 v152, v154
    v_permlane16_swap_b32 v153, v155
    s_nop 1
    buffer_store_dwordx4 v[152:155], v24, s[52:55], s83 offen sc0 sc1
    s_waitcnt lgkmcnt(0)
    v_pk_add_f32 v[96:97], v[96:97], v[136:137]
    v_pk_add_f32 v[98:99], v[98:99], v[138:139]
    v_pk_fma_f32 v[96:97], v[16:17], v[224:225], v[96:97]
    v_pk_fma_f32 v[98:99], v[16:17], v[226:227], v[98:99]
    v_pk_mul_f32 v[100:101], v[96:97], v[18:19]
    v_pk_mul_f32 v[102:103], v[98:99], v[18:19]
    v_exp_f32 v100, v100
    v_exp_f32 v101, v101
    v_exp_f32 v102, v102
    v_exp_f32 v103, v103
    s_nop 0
    v_pk_fma_f32 v[100:101], v[100:101], v[20:21], v[20:21]
    v_pk_fma_f32 v[102:103], v[102:103], v[20:21], v[20:21]
    v_rcp_f32 v100, v100
    v_rcp_f32 v101, v101
    v_rcp_f32 v102, v102
    v_rcp_f32 v103, v103
    s_nop 0
    v_pk_mul_f32 v[96:97], v[96:97], v[100:101]
    v_pk_mul_f32 v[98:99], v[98:99], v[102:103]
    v_cvt_pk_bf16_f32 v156, v96, v97
    v_cvt_pk_bf16_f32 v157, v98, v99
    buffer_store_dwordx2 v[156:157], v25, s[52:55], 0 offen sc0 sc1
    s_mov_b32 s79, s63
    s_cmp_lt_u32 s60, 4
    s_cbranch_scc1 g1na_16
    s_waitcnt lgkmcnt(0)
    ds_read_b32 v5, v26
    s_lshr_b32 s68, s60, 1
    s_and_b32 s68, s68, 1
    s_add_u32 s68, s68, s90
    s_lshl_b32 s68, s68, 12
    s_add_u32 s68, s68, 10485760
    s_and_b32 s69, s60, 1
    s_lshl_b32 s69, s69, 11
    v_add_u32 v4, s69, v2
    s_waitcnt lgkmcnt(0)
    v_readfirstlane_b32 s88, v5
    s_cmp_eq_u32 s88, 0
    s_cbranch_scc1 g1na_16
    buffer_load_dwordx4 v[188:191], v4, s[52:55], s68 offen sc1
    buffer_load_dwordx4 v[204:207], v4, s[52:55], s68 offen offset:1024 sc1
    s_waitcnt vmcnt(2)
    s_branch g1wt_17

g1na_16:
    s_waitcnt vmcnt(0)
g1wt_17:
    v_mov_b32 v5, 161552
    v_mov_b32 v6, 1
    s_mov_b64 exec, 1
    ds_add_rtn_u32 v7, v5, v6
    s_mov_b64 exec, -1
    s_waitcnt lgkmcnt(0)
    v_readfirstlane_b32 s68, v7
    s_cmp_lg_u32 s68, 7
    s_cbranch_scc1 hnl_18

    v_mov_b32 v5, 161564
    ds_read_b32 v6, v5
    s_waitcnt lgkmcnt(0)
    v_readfirstlane_b32 s68, v6
    s_cmp_lg_u32 s68, 0
    s_cbranch_scc1 zok_19

    v_mov_b32 v5, 192
pg_20:
    buffer_load_dword v6, v5, s[56:59], 0 offen sc1
    s_waitcnt vmcnt(0)
    v_readfirstlane_b32 s68, v6
    s_cmp_lg_u32 s68, 0
    s_cbranch_scc1 pgd_21
    s_sleep 32
    s_add_u32 s96, s96, 1
    s_cmp_lt_u32 s96, 0x400000
    s_cbranch_scc1 pg_20

pgd_21:
    v_mov_b32 v5, 161564
    ds_write_b32 v5, v6

zok_19:
    s_lshl_b32 s68, s63, 8
    s_add_u32 s68, s68, 16875520
    v_mov_b32 v5, s68
    v_mov_b32 v6, 1
    s_mov_b64 exec, 1
    buffer_atomic_add v6, v5, s[52:55], 0 offen sc1
    s_mov_b64 exec, -1

hnl_18:
    s_cmp_lt_u32 s60, 4
    s_cbranch_scc1 p2_gemm
    v_mov_b32 v4, 161552

g1h8_22:
    ds_read_b32 v5, v4
    s_waitcnt lgkmcnt(0)
    v_readfirstlane_b32 s68, v5
    s_add_u32 s96, s96, 1
    s_cmp_ge_u32 s96, 0x400000
    s_cselect_b32 s68, 8, s68
    s_cmp_lt_u32 s68, 8
    s_cbranch_scc1 g1h8_22
    s_mul_i32 s69, s60, 6144
    s_add_u32 s69, s69, 103936
    v_add_u32 v3, s69, v2

    ds_read_b128 v[176:179], v3 offset:0
    ds_read_b128 v[180:183], v3 offset:1024
    ds_read_b128 v[184:187], v3 offset:2048
    ds_read_b128 v[192:195], v3 offset:3072
    ds_read_b128 v[196:199], v3 offset:4096
    ds_read_b128 v[200:203], v3 offset:5120
    s_waitcnt lgkmcnt(0)
p2_conv:
    s_setprio 3
    s_and_b32 s62, s60, 1
    s_lshr_b32 s61, s60, 1
    s_and_b32 s61, s61, 1
    s_add_u32 s90, s90, s61
    s_mov_b32 s97, 0
    v_and_b32 v1, 63, v0
    s_mul_i32 s65, s61, 21248
    s_add_u32 s65, s65, 86016
    v_lshlrev_b32 v6, 4, v1
    s_lshl_b32 s63, s62, 11
    v_add_u32 v2, s63, v6
    v_add_u32 v20, s65, v2
    v_mov_b32 v12, 0
    v_mov_b32 v13, 0
    v_mov_b32 v14, 0
    v_mov_b32 v15, 0
    v_and_b32 v3, 15, v1
    v_lshrrev_b32 v4, 4, v1
    v_and_b32 v5, 3, v3
    v_mul_u32_u24 v8, 4160, v5
    v_lshrrev_b32 v5, 2, v3
    v_lshl_add_u32 v8, v5, 3, v8
    v_lshl_add_u32 v8, v4, 4, v8
    s_lshl_b32 s64, s62, 8
    s_add_u32 s64, s64, s65
    s_add_u32 s63, s64, 4608
    v_add_u32 v8, s63, v8
    v_lshlrev_b32 v9, 4, v4
    v_lshlrev_b32 v5, 5, v3
    v_sub_u32 v9, v9, v5
    s_add_u32 s63, s64, 480
    v_add_u32 v9, s63, v9
    v_add_u32 v6, 128512, v6
    s_and_b32 s63, s60, 3
    s_lshl_b32 s63, s63, 13
    v_add_u32 v16, s63, v6
    s_lshl_b32 s63, s61, 14
    s_lshl_b32 s64, s62, 12
    s_add_u32 s63, s63, s64
    v_add_u32 v17, s63, v6
    v_lshl_add_u32 v5, v4, 3, v5
    s_lshl_b32 s63, s62, 11
    s_sub_u32 s64, s65, s63
    s_add_u32 s64, s64, 2552
    v_sub_u32 v19, s64, v5
    v_add_u32 v18, s63, v5

ccloop_23:
    s_lshr_b32 s64, s90, 1
    s_lshl_b32 s64, s64, 2
    s_load_dword s68, s[14:15], s64

    v_alignbit_b32 v24, v196, v192, 16
    v_alignbit_b32 v25, v197, v193, 16
    v_alignbit_b32 v26, v198, v194, 16
    v_alignbit_b32 v27, v199, v195, 16
    v_alignbit_b32 v28, v200, v196, 16
    v_alignbit_b32 v29, v201, v197, 16
    v_alignbit_b32 v30, v202, v198, 16
    v_alignbit_b32 v31, v203, v199, 16
    ds_write_b128 v20, v[24:27] offset:5664
    ds_write_b128 v20, v[196:199] offset:9824
    ds_write_b128 v20, v[28:31] offset:13984
    ds_write_b128 v20, v[200:203] offset:18144

    v_alignbit_b32 v160, v180, v176, 16
    v_alignbit_b32 v161, v181, v177, 16
    v_alignbit_b32 v162, v182, v178, 16
    v_alignbit_b32 v163, v183, v179, 16
    v_alignbit_b32 v164, v184, v180, 16
    v_alignbit_b32 v165, v185, v181, 16
    v_alignbit_b32 v166, v186, v182, 16
    v_alignbit_b32 v167, v187, v183, 16
    ds_write_b128 v20, v[160:163] offset:4640
    ds_write_b128 v20, v[180:183] offset:8800
    ds_write_b128 v20, v[164:167] offset:12960
    ds_write_b128 v20, v[184:187] offset:17120

    s_cmp_lg_u32 s62, 0
    s_cbranch_scc1 ccq0_24
    s_mov_b32 exec_hi, 0
    ds_write_b128 v20, v[12:15] offset:4096
    s_mov_b64 exec, 1
    v_lshlrev_b32 v5, 16, v176
    v_mov_b32 v4, 0
    v_mov_b32 v6, 0
    v_mov_b32 v7, v176
    v_mov_b32 v10, v5
    v_mov_b32 v11, v160

    ds_write_b128 v20, v[12:15] offset:4608
    ds_write_b64 v20, v[12:13] offset:4624
    ds_write_b128 v20, v[12:15] offset:8768
    ds_write_b64 v20, v[12:13] offset:8784
    ds_write_b128 v20, v[12:15] offset:12928
    ds_write_b64 v20, v[12:13] offset:12944
    ds_write_b128 v20, v[12:15] offset:17088
    ds_write_b64 v20, v[12:13] offset:17104
    ds_write_b64 v20, v[4:5] offset:4632
    ds_write_b64 v20, v[6:7] offset:8792
    ds_write_b64 v20, v[10:11] offset:12952
    ds_write_b64 v20, v[176:177] offset:17112
    s_mov_b64 exec, -1

ccq0_24:
    s_cmp_lg_u32 s60, 7
    s_cbranch_scc1 cc7_25

    v_mov_b32 v5, 161540
    ds_read_b32 v4, v5
    s_waitcnt lgkmcnt(0)
    v_readfirstlane_b32 s63, v4
    s_cmp_lg_u32 s63, 0
    s_cbranch_scc1 w7ok_26

    v_mov_b32 v3, 128
pg_27:
    buffer_load_dword v4, v3, s[56:59], 0 offen sc1
    s_waitcnt vmcnt(0)
    v_readfirstlane_b32 s63, v4
    s_cmp_lg_u32 s63, 0
    s_cbranch_scc1 pgd_28
    s_sleep 12
    s_add_u32 s96, s96, 1
    s_cmp_lt_u32 s96, 0x400000
    s_cbranch_scc1 pg_27

pgd_28:
    v_mov_b32 v4, 1
    ds_write_b32 v5, v4
    s_waitcnt lgkmcnt(0)

w7ok_26:
cc7_25:
    s_cmp_lg_u32 s88, 0
    s_cbranch_scc1 ccu_29
    v_mov_b32 v3, 161540
wg_31:
    ds_read_b32 v4, v3
    s_waitcnt lgkmcnt(0)
    v_readfirstlane_b32 s63, v4
    s_cmp_lg_u32 s63, 0
    s_cbranch_scc1 wgd_32
    s_sleep 2
    s_add_u32 s96, s96, 1
    s_cmp_lt_u32 s96, 0x400000
    s_cbranch_scc1 wg_31

wgd_32:
    s_lshl_b32 s63, s90, 12
    s_add_u32 s63, s63, 10485760
    buffer_load_dwordx4 v[188:191], v2, s[52:55], s63 offen sc1
    buffer_load_dwordx4 v[204:207], v2, s[52:55], s63 offen offset:1024 sc1
    s_mov_b32 s88, 1
    s_cmp_lt_u32 s91, 2
    s_cbranch_scc1 ccu_29
    s_add_u32 s63, s63, 8192
    buffer_load_dwordx4 v[220:223], v2, s[52:55], s63 offen sc1
    buffer_load_dwordx4 v[236:239], v2, s[52:55], s63 offen offset:1024 sc1

ccu_29:
    s_cmp_lg_u32 s97, 0
    s_cbranch_scc1 ccu2_30
    s_waitcnt vmcnt(0)

ccu2_30:
    ds_write_b128 v20, v[188:191]
    ds_write_b128 v20, v[204:207] offset:1024
    s_waitcnt lgkmcnt(0)
    s_and_b32 s63, s90, 1
    s_lshl_b32 s63, s63, 4
    s_lshr_b32 s68, s68, s63
    s_lshl_b32 s68, s68, 16
    s_lshl_b32 s69, s90, 12
    s_add_u32 s69, s69, 13631488

    v_mov_b32 v32, 0
    v_mov_b32 v33, 0
    v_mov_b32 v34, 0
    v_mov_b32 v35, 0
    v_mov_b32 v36, 0
    v_mov_b32 v37, 0
    v_mov_b32 v38, 0
    v_mov_b32 v39, 0
    v_mov_b32 v40, 0
    v_mov_b32 v41, 0
    v_mov_b32 v42, 0
    v_mov_b32 v43, 0
    v_mov_b32 v44, 0
    v_mov_b32 v45, 0
    v_mov_b32 v46, 0
    v_mov_b32 v47, 0
    v_mov_b32 v48, 0
    v_mov_b32 v49, 0
    v_mov_b32 v50, 0
    v_mov_b32 v51, 0
    v_mov_b32 v52, 0
    v_mov_b32 v53, 0
    v_mov_b32 v54, 0
    v_mov_b32 v55, 0
    v_mov_b32 v56, 0
    v_mov_b32 v57, 0
    v_mov_b32 v58, 0
    v_mov_b32 v59, 0
    v_mov_b32 v60, 0
    v_mov_b32 v61, 0
    v_mov_b32 v62, 0
    v_mov_b32 v63, 0
    s_add_u32 s97, s97, 4
    v_mov_b32 v3, 161560
    v_mov_b32 v4, 1
    s_waitcnt lgkmcnt(0)
    s_mov_b64 exec, 1
    ds_add_u32 v3, v4
    s_mov_b64 exec, -1

gb_33:
    ds_read_b32 v4, v3
    s_waitcnt lgkmcnt(0)
    v_readfirstlane_b32 s63, v4
    s_add_u32 s96, s96, 1
    s_cmp_ge_u32 s96, 0x400000
    s_cselect_b32 s63, s97, s63
    s_cmp_lt_u32 s63, s97
    s_cbranch_scc1 gb_33

    s_setprio 1
    ds_read_b64 v[92:93], v8 offset:3584
    ds_read_b64 v[94:95], v8 offset:3592
    ds_read_b128 v[96:99], v9 offset:3584
    ds_read_b64 v[88:89], v8 offset:3072
    ds_read_b64 v[90:91], v8 offset:3080
    ds_read_b128 v[100:103], v9 offset:3072
    ds_read_b64 v[84:85], v8 offset:2560
    ds_read_b64 v[86:87], v8 offset:2568
    ds_read_b128 v[104:107], v9 offset:2560
    ds_read_b64 v[80:81], v8 offset:2048
    ds_read_b64 v[82:83], v8 offset:2056
    ds_read_b128 v[108:111], v9 offset:2048
    ds_read_b64 v[76:77], v8 offset:1536
    ds_read_b64 v[78:79], v8 offset:1544
    ds_read_b128 v[112:115], v9 offset:1536
    ds_read_b64 v[72:73], v8 offset:1024
    ds_read_b64 v[74:75], v8 offset:1032
    ds_read_b128 v[116:119], v9 offset:1024
    ds_read_b64 v[68:69], v8 offset:512
    ds_read_b64 v[70:71], v8 offset:520
    ds_read_b128 v[120:123], v9 offset:512
    ds_read_b64 v[64:65], v8 offset:0
    ds_read_b64 v[66:67], v8 offset:8
    ds_read_b128 v[124:127], v9 offset:0
    s_mov_b32 s70, 0
ccin_34:
    s_waitcnt lgkmcnt(15)
    v_mfma_f32_16x16x32_bf16 v[60:63], v[92:95], v[96:99], v[60:63]
    ds_read_b64 v[92:93], v8 offset:3648
    ds_read_b64 v[94:95], v8 offset:3656
    ds_read_b128 v[128:131], v9 offset:3648
    v_mfma_f32_16x16x32_bf16 v[56:59], v[88:91], v[96:99], v[56:59]
    v_mfma_f32_16x16x32_bf16 v[60:63], v[88:91], v[100:103], v[60:63]
    ds_read_b64 v[88:89], v8 offset:3136
    ds_read_b64 v[90:91], v8 offset:3144
    ds_read_b128 v[132:135], v9 offset:3136
    v_mfma_f32_16x16x32_bf16 v[52:55], v[84:87], v[96:99], v[52:55]
    v_mfma_f32_16x16x32_bf16 v[56:59], v[84:87], v[100:103], v[56:59]
    v_mfma_f32_16x16x32_bf16 v[60:63], v[84:87], v[104:107], v[60:63]
    ds_read_b64 v[84:85], v8 offset:2624
    ds_read_b64 v[86:87], v8 offset:2632
    ds_read_b128 v[136:139], v9 offset:2624
    s_waitcnt lgkmcnt(15)
    v_mfma_f32_16x16x32_bf16 v[48:51], v[80:83], v[96:99], v[48:51]
    v_mfma_f32_16x16x32_bf16 v[52:55], v[80:83], v[100:103], v[52:55]
    v_mfma_f32_16x16x32_bf16 v[56:59], v[80:83], v[104:107], v[56:59]
    v_mfma_f32_16x16x32_bf16 v[60:63], v[80:83], v[108:111], v[60:63]
    ds_read_b64 v[80:81], v8 offset:2112
    ds_read_b64 v[82:83], v8 offset:2120
    ds_read_b128 v[140:143], v9 offset:2112
    v_mfma_f32_16x16x32_bf16 v[44:47], v[76:79], v[96:99], v[44:47]
    v_mfma_f32_16x16x32_bf16 v[48:51], v[76:79], v[100:103], v[48:51]
    v_mfma_f32_16x16x32_bf16 v[52:55], v[76:79], v[104:107], v[52:55]
    v_mfma_f32_16x16x32_bf16 v[56:59], v[76:79], v[108:111], v[56:59]
    v_mfma_f32_16x16x32_bf16 v[60:63], v[76:79], v[112:115], v[60:63]
    ds_read_b64 v[76:77], v8 offset:1600
    ds_read_b64 v[78:79], v8 offset:1608
    ds_read_b128 v[144:147], v9 offset:1600
    v_mfma_f32_16x16x32_bf16 v[40:43], v[72:75], v[96:99], v[40:43]
    v_mfma_f32_16x16x32_bf16 v[44:47], v[72:75], v[100:103], v[44:47]
    v_mfma_f32_16x16x32_bf16 v[48:51], v[72:75], v[104:107], v[48:51]
    v_mfma_f32_16x16x32_bf16 v[52:55], v[72:75], v[108:111], v[52:55]
    v_mfma_f32_16x16x32_bf16 v[56:59], v[72:75], v[112:115], v[56:59]
    v_mfma_f32_16x16x32_bf16 v[60:63], v[72:75], v[116:119], v[60:63]
    ds_read_b64 v[72:73], v8 offset:1088
    ds_read_b64 v[74:75], v8 offset:1096
    ds_read_b128 v[148:151], v9 offset:1088
    s_waitcnt lgkmcnt(15)
    v_mfma_f32_16x16x32_bf16 v[36:39], v[68:71], v[96:99], v[36:39]
    v_mfma_f32_16x16x32_bf16 v[40:43], v[68:71], v[100:103], v[40:43]
    v_mfma_f32_16x16x32_bf16 v[44:47], v[68:71], v[104:107], v[44:47]
    v_mfma_f32_16x16x32_bf16 v[48:51], v[68:71], v[108:111], v[48:51]
    v_mfma_f32_16x16x32_bf16 v[52:55], v[68:71], v[112:115], v[52:55]
    v_mfma_f32_16x16x32_bf16 v[56:59], v[68:71], v[116:119], v[56:59]
    v_mfma_f32_16x16x32_bf16 v[60:63], v[68:71], v[120:123], v[60:63]
    ds_read_b64 v[68:69], v8 offset:576
    ds_read_b64 v[70:71], v8 offset:584
    ds_read_b128 v[152:155], v9 offset:576
    v_mfma_f32_16x16x32_bf16 v[32:35], v[64:67], v[96:99], v[32:35]
    v_mfma_f32_16x16x32_bf16 v[36:39], v[64:67], v[100:103], v[36:39]
    v_mfma_f32_16x16x32_bf16 v[40:43], v[64:67], v[104:107], v[40:43]
    v_mfma_f32_16x16x32_bf16 v[44:47], v[64:67], v[108:111], v[44:47]
    v_mfma_f32_16x16x32_bf16 v[48:51], v[64:67], v[112:115], v[48:51]
    v_mfma_f32_16x16x32_bf16 v[52:55], v[64:67], v[116:119], v[52:55]
    v_mfma_f32_16x16x32_bf16 v[56:59], v[64:67], v[120:123], v[56:59]
    v_mfma_f32_16x16x32_bf16 v[60:63], v[64:67], v[124:127], v[60:63]
    ds_read_b64 v[64:65], v8 offset:64
    ds_read_b64 v[66:67], v8 offset:72
    ds_read_b128 v[156:159], v9 offset:64
    v_mfma_f32_16x16x32_bf16 v[60:63], v[92:95], v[128:131], v[60:63]
    ds_read_b64 v[92:93], v8 offset:3712
    ds_read_b64 v[94:95], v8 offset:3720
    ds_read_b128 v[96:99], v9 offset:3712
    s_waitcnt lgkmcnt(15)
    v_mfma_f32_16x16x32_bf16 v[56:59], v[88:91], v[128:131], v[56:59]
    v_mfma_f32_16x16x32_bf16 v[60:63], v[88:91], v[132:135], v[60:63]
    ds_read_b64 v[88:89], v8 offset:3200
    ds_read_b64 v[90:91], v8 offset:3208
    ds_read_b128 v[100:103], v9 offset:3200
    v_mfma_f32_16x16x32_bf16 v[52:55], v[84:87], v[128:131], v[52:55]
    v_mfma_f32_16x16x32_bf16 v[56:59], v[84:87], v[132:135], v[56:59]
    v_mfma_f32_16x16x32_bf16 v[60:63], v[84:87], v[136:139], v[60:63]
    ds_read_b64 v[84:85], v8 offset:2688
    ds_read_b64 v[86:87], v8 offset:2696
    ds_read_b128 v[104:107], v9 offset:2688
    v_mfma_f32_16x16x32_bf16 v[48:51], v[80:83], v[128:131], v[48:51]
    v_mfma_f32_16x16x32_bf16 v[52:55], v[80:83], v[132:135], v[52:55]
    v_mfma_f32_16x16x32_bf16 v[56:59], v[80:83], v[136:139], v[56:59]
    v_mfma_f32_16x16x32_bf16 v[60:63], v[80:83], v[140:143], v[60:63]
    ds_read_b64 v[80:81], v8 offset:2176
    ds_read_b64 v[82:83], v8 offset:2184
    ds_read_b128 v[108:111], v9 offset:2176
    s_waitcnt lgkmcnt(15)
    v_mfma_f32_16x16x32_bf16 v[44:47], v[76:79], v[128:131], v[44:47]
    v_mfma_f32_16x16x32_bf16 v[48:51], v[76:79], v[132:135], v[48:51]
    v_mfma_f32_16x16x32_bf16 v[52:55], v[76:79], v[136:139], v[52:55]
    v_mfma_f32_16x16x32_bf16 v[56:59], v[76:79], v[140:143], v[56:59]
    v_mfma_f32_16x16x32_bf16 v[60:63], v[76:79], v[144:147], v[60:63]
    ds_read_b64 v[76:77], v8 offset:1664
    ds_read_b64 v[78:79], v8 offset:1672
    ds_read_b128 v[112:115], v9 offset:1664
    v_mfma_f32_16x16x32_bf16 v[40:43], v[72:75], v[128:131], v[40:43]
    v_mfma_f32_16x16x32_bf16 v[44:47], v[72:75], v[132:135], v[44:47]
    v_mfma_f32_16x16x32_bf16 v[48:51], v[72:75], v[136:139], v[48:51]
    v_mfma_f32_16x16x32_bf16 v[52:55], v[72:75], v[140:143], v[52:55]
    v_mfma_f32_16x16x32_bf16 v[56:59], v[72:75], v[144:147], v[56:59]
    v_mfma_f32_16x16x32_bf16 v[60:63], v[72:75], v[148:151], v[60:63]
    ds_read_b64 v[72:73], v8 offset:1152
    ds_read_b64 v[74:75], v8 offset:1160
    ds_read_b128 v[116:119], v9 offset:1152
    v_mfma_f32_16x16x32_bf16 v[36:39], v[68:71], v[128:131], v[36:39]
    v_mfma_f32_16x16x32_bf16 v[40:43], v[68:71], v[132:135], v[40:43]
    v_mfma_f32_16x16x32_bf16 v[44:47], v[68:71], v[136:139], v[44:47]
    v_mfma_f32_16x16x32_bf16 v[48:51], v[68:71], v[140:143], v[48:51]
    v_mfma_f32_16x16x32_bf16 v[52:55], v[68:71], v[144:147], v[52:55]
    v_mfma_f32_16x16x32_bf16 v[56:59], v[68:71], v[148:151], v[56:59]
    v_mfma_f32_16x16x32_bf16 v[60:63], v[68:71], v[152:155], v[60:63]
    ds_read_b64 v[68:69], v8 offset:640
    ds_read_b64 v[70:71], v8 offset:648
    ds_read_b128 v[120:123], v9 offset:640
    s_waitcnt lgkmcnt(15)
    v_mfma_f32_16x16x32_bf16 v[32:35], v[64:67], v[128:131], v[32:35]
    v_mfma_f32_16x16x32_bf16 v[36:39], v[64:67], v[132:135], v[36:39]
    v_mfma_f32_16x16x32_bf16 v[40:43], v[64:67], v[136:139], v[40:43]
    v_mfma_f32_16x16x32_bf16 v[44:47], v[64:67], v[140:143], v[44:47]
    v_mfma_f32_16x16x32_bf16 v[48:51], v[64:67], v[144:147], v[48:51]
    v_mfma_f32_16x16x32_bf16 v[52:55], v[64:67], v[148:151], v[52:55]
    v_mfma_f32_16x16x32_bf16 v[56:59], v[64:67], v[152:155], v[56:59]
    v_mfma_f32_16x16x32_bf16 v[60:63], v[64:67], v[156:159], v[60:63]
    ds_read_b64 v[64:65], v8 offset:128
    ds_read_b64 v[66:67], v8 offset:136
    ds_read_b128 v[124:127], v9 offset:128
    v_add_u32 v8, 128, v8
    v_add_u32 v9, 128, v9
    s_add_u32 s70, s70, 1
    s_cmp_lt_u32 s70, 2
    s_cbranch_scc1 ccin_34
    s_setprio 3
    v_subrev_u32 v8, 256, v8
    v_subrev_u32 v9, 256, v9

    ds_read_b64 v[168:169], v19 offset:1536
    ds_read_b64 v[170:171], v19 offset:1024
    ds_read_b64 v[172:173], v19 offset:512
    ds_read_b64 v[174:175], v19 offset:0
    ds_write_b128 v16, v[32:35] offset:0
    ds_write_b128 v16, v[36:39] offset:1024
    ds_write_b128 v16, v[40:43] offset:2048
    ds_write_b128 v16, v[44:47] offset:3072
    ds_write_b128 v16, v[48:51] offset:4096
    ds_write_b128 v16, v[52:55] offset:5120
    ds_write_b128 v16, v[56:59] offset:6144
    ds_write_b128 v16, v[60:63] offset:7168
    v_mov_b32 v176, v208
    v_mov_b32 v177, v209
    v_mov_b32 v178, v210
    v_mov_b32 v179, v211
    v_mov_b32 v180, v212
    v_mov_b32 v181, v213
    v_mov_b32 v182, v214
    v_mov_b32 v183, v215
    v_mov_b32 v184, v216
    v_mov_b32 v185, v217
    v_mov_b32 v186, v218
    v_mov_b32 v187, v219
    v_mov_b32 v188, v220
    v_mov_b32 v189, v221
    v_mov_b32 v190, v222
    v_mov_b32 v191, v223
    v_mov_b32 v192, v224
    v_mov_b32 v193, v225
    v_mov_b32 v194, v226
    v_mov_b32 v195, v227
    v_mov_b32 v196, v228
    v_mov_b32 v197, v229
    v_mov_b32 v198, v230
    v_mov_b32 v199, v231
    v_mov_b32 v200, v232
    v_mov_b32 v201, v233
    v_mov_b32 v202, v234
    v_mov_b32 v203, v235
    v_mov_b32 v204, v236
    v_mov_b32 v205, v237
    v_mov_b32 v206, v238
    v_mov_b32 v207, v239
    s_add_u32 s97, s97, 4
    v_mov_b32 v3, 161560
    v_mov_b32 v4, 1
    s_waitcnt lgkmcnt(0)
    s_mov_b64 exec, 1
    ds_add_u32 v3, v4
    s_mov_b64 exec, -1

gb_35:
    ds_read_b32 v4, v3
    s_waitcnt lgkmcnt(0)
    v_readfirstlane_b32 s63, v4
    s_add_u32 s96, s96, 1
    s_cmp_ge_u32 s96, 0x400000
    s_cselect_b32 s63, s97, s63
    s_cmp_lt_u32 s63, s97
    s_cbranch_scc1 gb_35

    ds_read_b128 v[64:67], v17 offset:0
    ds_read_b128 v[68:71], v17 offset:8192
    ds_read_b128 v[72:75], v17 offset:1024
    ds_read_b128 v[76:79], v17 offset:9216
    ds_read_b128 v[80:83], v17 offset:2048
    ds_read_b128 v[84:87], v17 offset:10240
    ds_read_b128 v[88:91], v17 offset:3072
    ds_read_b128 v[92:95], v17 offset:11264
    v_and_b32 v96, 0xffff0000, v169
    v_lshlrev_b32 v97, 16, v169
    v_and_b32 v98, 0xffff0000, v168
    v_lshlrev_b32 v99, 16, v168
    v_mul_f32 v96, s68, v96
    v_mul_f32 v97, s68, v97
    v_mul_f32 v98, s68, v98
    v_mul_f32 v99, s68, v99
    v_cvt_pk_bf16_f32 v100, v96, v97
    v_cvt_pk_bf16_f32 v101, v98, v99
    v_lshlrev_b32 v96, 16, v100
    v_and_b32 v97, 0xffff0000, v100
    v_lshlrev_b32 v98, 16, v101
    v_and_b32 v99, 0xffff0000, v101
    s_waitcnt lgkmcnt(6)
    v_pk_add_f32 v[64:65], v[64:65], v[68:69]
    v_pk_add_f32 v[66:67], v[66:67], v[70:71]
    v_cvt_pk_bf16_f32 v68, v64, v65
    v_cvt_pk_bf16_f32 v69, v66, v67
    v_lshlrev_b32 v64, 16, v68
    v_and_b32 v65, 0xffff0000, v68
    v_lshlrev_b32 v66, 16, v69
    v_and_b32 v67, 0xffff0000, v69
    v_pk_add_f32 v[64:65], v[64:65], v[96:97]
    v_pk_add_f32 v[66:67], v[66:67], v[98:99]
    v_cvt_pk_bf16_f32 v128, v64, v65
    v_cvt_pk_bf16_f32 v129, v66, v67
    buffer_store_dwordx2 v[128:129], v18, s[52:55], s69 offen offset:0 sc0 sc1
    v_and_b32 v104, 0xffff0000, v171
    v_lshlrev_b32 v105, 16, v171
    v_and_b32 v106, 0xffff0000, v170
    v_lshlrev_b32 v107, 16, v170
    v_mul_f32 v104, s68, v104
    v_mul_f32 v105, s68, v105
    v_mul_f32 v106, s68, v106
    v_mul_f32 v107, s68, v107
    v_cvt_pk_bf16_f32 v108, v104, v105
    v_cvt_pk_bf16_f32 v109, v106, v107
    v_lshlrev_b32 v104, 16, v108
    v_and_b32 v105, 0xffff0000, v108
    v_lshlrev_b32 v106, 16, v109
    v_and_b32 v107, 0xffff0000, v109
    s_waitcnt lgkmcnt(4)
    v_pk_add_f32 v[72:73], v[72:73], v[76:77]
    v_pk_add_f32 v[74:75], v[74:75], v[78:79]
    v_cvt_pk_bf16_f32 v76, v72, v73
    v_cvt_pk_bf16_f32 v77, v74, v75
    v_lshlrev_b32 v72, 16, v76
    v_and_b32 v73, 0xffff0000, v76
    v_lshlrev_b32 v74, 16, v77
    v_and_b32 v75, 0xffff0000, v77
    v_pk_add_f32 v[72:73], v[72:73], v[104:105]
    v_pk_add_f32 v[74:75], v[74:75], v[106:107]
    v_cvt_pk_bf16_f32 v130, v72, v73
    v_cvt_pk_bf16_f32 v131, v74, v75
    buffer_store_dwordx2 v[130:131], v18, s[52:55], s69 offen offset:512 sc0 sc1
    v_and_b32 v112, 0xffff0000, v173
    v_lshlrev_b32 v113, 16, v173
    v_and_b32 v114, 0xffff0000, v172
    v_lshlrev_b32 v115, 16, v172
    v_mul_f32 v112, s68, v112
    v_mul_f32 v113, s68, v113
    v_mul_f32 v114, s68, v114
    v_mul_f32 v115, s68, v115
    v_cvt_pk_bf16_f32 v116, v112, v113
    v_cvt_pk_bf16_f32 v117, v114, v115
    v_lshlrev_b32 v112, 16, v116
    v_and_b32 v113, 0xffff0000, v116
    v_lshlrev_b32 v114, 16, v117
    v_and_b32 v115, 0xffff0000, v117
    s_waitcnt lgkmcnt(2)
    v_pk_add_f32 v[80:81], v[80:81], v[84:85]
    v_pk_add_f32 v[82:83], v[82:83], v[86:87]
    v_cvt_pk_bf16_f32 v84, v80, v81
    v_cvt_pk_bf16_f32 v85, v82, v83
    v_lshlrev_b32 v80, 16, v84
    v_and_b32 v81, 0xffff0000, v84
    v_lshlrev_b32 v82, 16, v85
    v_and_b32 v83, 0xffff0000, v85
    v_pk_add_f32 v[80:81], v[80:81], v[112:113]
    v_pk_add_f32 v[82:83], v[82:83], v[114:115]
    v_cvt_pk_bf16_f32 v132, v80, v81
    v_cvt_pk_bf16_f32 v133, v82, v83
    buffer_store_dwordx2 v[132:133], v18, s[52:55], s69 offen offset:1024 sc0 sc1
    v_and_b32 v120, 0xffff0000, v175
    v_lshlrev_b32 v121, 16, v175
    v_and_b32 v122, 0xffff0000, v174
    v_lshlrev_b32 v123, 16, v174
    v_mul_f32 v120, s68, v120
    v_mul_f32 v121, s68, v121
    v_mul_f32 v122, s68, v122
    v_mul_f32 v123, s68, v123
    v_cvt_pk_bf16_f32 v124, v120, v121
    v_cvt_pk_bf16_f32 v125, v122, v123
    v_lshlrev_b32 v120, 16, v124
    v_and_b32 v121, 0xffff0000, v124
    v_lshlrev_b32 v122, 16, v125
    v_and_b32 v123, 0xffff0000, v125
    s_waitcnt lgkmcnt(0)
    v_pk_add_f32 v[88:89], v[88:89], v[92:93]
    v_pk_add_f32 v[90:91], v[90:91], v[94:95]
    v_cvt_pk_bf16_f32 v92, v88, v89
    v_cvt_pk_bf16_f32 v93, v90, v91
    v_lshlrev_b32 v88, 16, v92
    v_and_b32 v89, 0xffff0000, v92
    v_lshlrev_b32 v90, 16, v93
    v_and_b32 v91, 0xffff0000, v93
    v_pk_add_f32 v[88:89], v[88:89], v[120:121]
    v_pk_add_f32 v[90:91], v[90:91], v[122:123]
    v_cvt_pk_bf16_f32 v134, v88, v89
    v_cvt_pk_bf16_f32 v135, v90, v91
    buffer_store_dwordx2 v[134:135], v18, s[52:55], s69 offen offset:1536 sc0 sc1
    s_add_u32 s90, s90, 2
    s_sub_u32 s91, s91, 1
    s_cmp_lg_u32 s91, 0
    s_cbranch_scc1 ccloop_23

    s_waitcnt vmcnt(0)
    v_mov_b32 v2, 161556
    v_mov_b32 v3, 1
    s_mov_b64 exec, 1
    ds_add_rtn_u32 v4, v2, v3
    s_mov_b64 exec, -1
    s_waitcnt lgkmcnt(0)
    v_readfirstlane_b32 s62, v4
    s_cmp_lg_u32 s62, 3
    s_cbranch_scc1 ynl_36

    v_mov_b32 v2, 161564
    ds_read_b32 v3, v2
    s_waitcnt lgkmcnt(0)
    v_readfirstlane_b32 s62, v3
    s_cmp_lg_u32 s62, 0
    s_cbranch_scc1 zok_37

    v_mov_b32 v2, 192
pg_38:
    buffer_load_dword v3, v2, s[56:59], 0 offen sc1
    s_waitcnt vmcnt(0)
    v_readfirstlane_b32 s62, v3
    s_cmp_lg_u32 s62, 0
    s_cbranch_scc1 pgd_39
    s_sleep 32
    s_add_u32 s96, s96, 1
    s_cmp_lt_u32 s96, 0x400000
    s_cbranch_scc1 pg_38

pgd_39:
    v_mov_b32 v2, 161564
    ds_write_b32 v2, v3

zok_37:
    s_sub_u32 s62, s2, 64
    s_lshl_b32 s62, s62, 1
    s_lshl_b32 s63, s2, 2
    s_add_u32 s63, s63, 384
    s_cmp_lt_u32 s2, 64
    s_cselect_b32 s62, s63, s62
    s_cselect_b32 s63, 4, 2
    s_mul_i32 s62, s62, 52429
    s_lshr_b32 s62, s62, 22
    s_lshl_b32 s62, s62, 8
    s_add_u32 s62, s62, 16879616
    v_mov_b32 v2, s62
    v_mov_b32 v3, s63
    s_mov_b64 exec, 1
    buffer_atomic_add v3, v2, s[52:55], 0 offen sc1
    s_mov_b64 exec, -1

ynl_36:
    s_cmp_lg_u32 s60, 7
    s_cbranch_scc1 ysx_40
    s_setprio 0
    s_and_b32 s62, s2, 7
    s_lshr_b32 s63, s2, 3
    s_lshr_b32 s64, s62, 1
    s_lshl_b32 s64, s64, 3
    s_and_b32 s65, s63, 7
    s_add_u32 s64, s64, s65
    s_and_b32 s62, s62, 1
    s_lshl_b32 s62, s62, 2
    s_lshr_b32 s63, s63, 3
    s_add_u32 s62, s62, s63
    s_lshl_b32 s63, s62, 8
    s_add_u32 s63, s63, 16879616
    v_mov_b32 v2, s63

    v_mov_b32 v4, 161564
    ds_read_b32 v5, v4
    s_waitcnt lgkmcnt(0)
    v_readfirstlane_b32 s63, v5
    s_cmp_lg_u32 s63, 0
    s_cbranch_scc1 zok_43

    v_mov_b32 v4, 192
pg_44:
    buffer_load_dword v5, v4, s[56:59], 0 offen sc1
    s_waitcnt vmcnt(0)
    v_readfirstlane_b32 s63, v5
    s_cmp_lg_u32 s63, 0
    s_cbranch_scc1 pgd_45
    s_sleep 32
    s_add_u32 s96, s96, 1
    s_cmp_lt_u32 s96, 0x400000
    s_cbranch_scc1 pg_44

pgd_45:
    v_mov_b32 v4, 161564
    ds_write_b32 v4, v5

zok_43:
ysp_41:
    buffer_load_dword v3, v2, s[52:55], 0 offen sc1
    s_waitcnt vmcnt(0)
    v_readfirstlane_b32 s63, v3
    s_cmp_ge_u32 s63, 80
    s_cbranch_scc1 ysd_42
    s_sleep 16
    s_add_u32 s96, s96, 1
    s_cmp_lt_u32 s96, 0x400000
    s_cbranch_scc1 ysp_41

ysd_42:
    s_setprio 3
    v_lshrrev_b32 v2, 3, v1
    v_and_b32 v3, 7, v1
    v_lshlrev_b32 v4, 12, v2
    v_lshl_add_u32 v4, v3, 4, v4
    v_lshrrev_b32 v5, 1, v3
    v_mul_u32_u24 v5, 2560, v5
    v_lshl_add_u32 v5, v2, 5, v5
    v_and_b32 v3, 1, v3
    v_lshl_add_u32 v5, v3, 4, v5
    v_add_u32 v5, 86016, v5
    s_mul_i32 s62, s62, 327680
    s_lshl_b32 s64, s64, 7
    s_add_u32 s62, s62, s64
    s_add_u32 s62, s62, 13631488

    buffer_load_dwordx4 v[32:35], v4, s[52:55], s62 offen sc0 sc1
    s_add_u32 s62, s62, 32768
    buffer_load_dwordx4 v[36:39], v4, s[52:55], s62 offen sc0 sc1
    s_add_u32 s62, s62, 32768
    buffer_load_dwordx4 v[40:43], v4, s[52:55], s62 offen sc0 sc1
    s_add_u32 s62, s62, 32768
    buffer_load_dwordx4 v[44:47], v4, s[52:55], s62 offen sc0 sc1
    s_add_u32 s62, s62, 32768
    buffer_load_dwordx4 v[48:51], v4, s[52:55], s62 offen sc0 sc1
    s_add_u32 s62, s62, 32768
    buffer_load_dwordx4 v[52:55], v4, s[52:55], s62 offen sc0 sc1
    s_add_u32 s62, s62, 32768
    buffer_load_dwordx4 v[56:59], v4, s[52:55], s62 offen sc0 sc1
    s_add_u32 s62, s62, 32768
    buffer_load_dwordx4 v[60:63], v4, s[52:55], s62 offen sc0 sc1
    s_add_u32 s62, s62, 32768
    buffer_load_dwordx4 v[64:67], v4, s[52:55], s62 offen sc0 sc1
    s_add_u32 s62, s62, 32768
    buffer_load_dwordx4 v[68:71], v4, s[52:55], s62 offen sc0 sc1
    s_add_u32 s62, s62, 32768
    s_waitcnt vmcnt(9)
    ds_write_b128 v5, v[32:35] offset:0
    s_waitcnt vmcnt(8)
    ds_write_b128 v5, v[36:39] offset:256
    s_waitcnt vmcnt(7)
    ds_write_b128 v5, v[40:43] offset:512
    s_waitcnt vmcnt(6)
    ds_write_b128 v5, v[44:47] offset:768
    s_waitcnt vmcnt(5)
    ds_write_b128 v5, v[48:51] offset:1024
    s_waitcnt vmcnt(4)
    ds_write_b128 v5, v[52:55] offset:1280
    s_waitcnt vmcnt(3)
    ds_write_b128 v5, v[56:59] offset:1536
    s_waitcnt vmcnt(2)
    ds_write_b128 v5, v[60:63] offset:1792
    s_waitcnt vmcnt(1)
    ds_write_b128 v5, v[64:67] offset:2048
    s_waitcnt vmcnt(0)
    ds_write_b128 v5, v[68:71] offset:2304
    s_waitcnt lgkmcnt(0)
ysx_40:
    s_endpgm
p2_gemm:
    s_mov_b32 s28, s4
    s_and_b32 s29, s5, 0xffff
    s_mov_b32 s30, 2621440
    s_mov_b32 s31, 0x00020000
    s_mov_b32 s32, s22
    s_and_b32 s33, s23, 0xffff
    s_mov_b32 s34, 2621440
    s_mov_b32 s35, 0x00020000
    v_and_b32 v1, 63, v0
    s_and_b32 s63, s2, 7
    s_lshr_b32 s64, s2, 3
    s_and_b32 s64, s64, 31
    s_lshr_b32 s61, s63, 1
    s_lshl_b32 s61, s61, 3
    s_and_b32 s65, s64, 7
    s_add_u32 s61, s61, s65
    s_and_b32 s62, s63, 1
    s_lshl_b32 s62, s62, 2
    s_lshr_b32 s65, s64, 3
    s_add_u32 s62, s62, s65
    s_min_u32 s63, s60, 2
    s_mul_i32 s64, s60, 13
    s_add_u32 s63, s63, s64
    s_mul_i32 s68, s61, 54
    s_add_u32 s68, s68, s63
    s_lshl_b32 s68, s68, 12
    s_mul_i32 s69, s62, 54
    s_add_u32 s69, s69, s63
    s_mul_i32 s69, s69, 5120
    s_add_u32 s69, s69, 7340032
    s_mov_b32 s71, s68
    s_mov_b32 s72, s69
    s_cmp_lt_u32 s60, 2
    s_cselect_b32 s70, 14, 13
    s_lshl_b32 s63, s70, 12
    s_add_u32 s73, s71, s63
    s_mul_i32 s63, s70, 5120
    s_add_u32 s74, s72, s63
    s_and_b32 s63, s61, 7
    s_mul_i32 s63, s63, 0
    s_and_b32 s64, s62, 3
    s_mul_i32 s64, s64, 0
    s_add_u32 s63, s63, s64
    s_cmp_ge_u32 s63, 13
    s_cselect_b32 s64, 13, 0
    s_sub_u32 s63, s63, s64
    s_lshl_b32 s64, s63, 12
    s_add_u32 s68, s68, s64
    s_mul_i32 s64, s63, 5120
    s_add_u32 s69, s69, s64
    v_lshlrev_b32 v2, 4, v1
    v_add_u32 v12, 4096, v2

    s_xor_b32 s63, s60, 0
    s_lshl_b32 s63, s63, 10
    v_add_u32 v8, s63, v2
    s_xor_b32 s63, s60, 1
    s_lshl_b32 s63, s63, 10
    v_add_u32 v9, s63, v2
    s_xor_b32 s63, s60, 2
    s_lshl_b32 s63, s63, 10
    v_add_u32 v10, s63, v2
    s_xor_b32 s63, s60, 3
    s_lshl_b32 s63, s63, 10
    v_add_u32 v11, s63, v2
    v_mov_b32 v16, 0
    v_mov_b32 v17, 0
    v_mov_b32 v18, 0
    v_mov_b32 v19, 0
    v_mov_b32 v20, 0
    v_mov_b32 v21, 0
    v_mov_b32 v22, 0
    v_mov_b32 v23, 0
    v_mov_b32 v24, 0
    v_mov_b32 v25, 0
    v_mov_b32 v26, 0
    v_mov_b32 v27, 0
    v_mov_b32 v28, 0
    v_mov_b32 v29, 0
    v_mov_b32 v30, 0
    v_mov_b32 v31, 0
    v_mov_b32 v32, 0
    v_mov_b32 v33, 0
    v_mov_b32 v34, 0
    v_mov_b32 v35, 0
    v_mov_b32 v36, 0
    v_mov_b32 v37, 0
    v_mov_b32 v38, 0
    v_mov_b32 v39, 0
    v_mov_b32 v40, 0
    v_mov_b32 v41, 0
    v_mov_b32 v42, 0
    v_mov_b32 v43, 0
    v_mov_b32 v44, 0
    v_mov_b32 v45, 0
    v_mov_b32 v46, 0
    v_mov_b32 v47, 0
    v_mov_b32 v48, 0
    v_mov_b32 v49, 0
    v_mov_b32 v50, 0
    v_mov_b32 v51, 0
    v_mov_b32 v52, 0
    v_mov_b32 v53, 0
    v_mov_b32 v54, 0
    v_mov_b32 v55, 0
    v_mov_b32 v56, 0
    v_mov_b32 v57, 0
    v_mov_b32 v58, 0
    v_mov_b32 v59, 0
    v_mov_b32 v60, 0
    v_mov_b32 v61, 0
    v_mov_b32 v62, 0
    v_mov_b32 v63, 0
    v_mov_b32 v64, 0
    v_mov_b32 v65, 0
    v_mov_b32 v66, 0
    v_mov_b32 v67, 0
    v_mov_b32 v68, 0
    v_mov_b32 v69, 0
    v_mov_b32 v70, 0
    v_mov_b32 v71, 0
    v_mov_b32 v72, 0
    v_mov_b32 v73, 0
    v_mov_b32 v74, 0
    v_mov_b32 v75, 0
    v_mov_b32 v76, 0
    v_mov_b32 v77, 0
    v_mov_b32 v78, 0
    v_mov_b32 v79, 0
    v_mov_b32 v80, 0
    v_mov_b32 v81, 0
    v_mov_b32 v82, 0
    v_mov_b32 v83, 0
    v_mov_b32 v84, 0
    v_mov_b32 v85, 0
    v_mov_b32 v86, 0
    v_mov_b32 v87, 0
    v_mov_b32 v88, 0
    v_mov_b32 v89, 0
    v_mov_b32 v90, 0
    v_mov_b32 v91, 0
    v_mov_b32 v92, 0
    v_mov_b32 v93, 0
    v_mov_b32 v94, 0
    v_mov_b32 v95, 0
    v_mov_b32 v4, 161536
    s_cmp_lg_u32 s60, 0
    s_cbranch_scc1 hoth_46
    ds_read_b32 v13, v4
    s_waitcnt lgkmcnt(0)
    v_readfirstlane_b32 s63, v13
    s_cmp_ge_u32 s63, 1
    s_cbranch_scc1 hgo_47

    v_mov_b32 v5, 161564
    ds_read_b32 v6, v5
    s_waitcnt lgkmcnt(0)
    v_readfirstlane_b32 s63, v6
    s_cmp_lg_u32 s63, 0
    s_cbranch_scc1 zok_48

    v_mov_b32 v5, 192
pg_49:
    buffer_load_dword v6, v5, s[56:59], 0 offen sc1
    s_waitcnt vmcnt(0)
    v_readfirstlane_b32 s63, v6
    s_cmp_lg_u32 s63, 0
    s_cbranch_scc1 pgd_50
    s_sleep 32
    s_add_u32 s96, s96, 1
    s_cmp_lt_u32 s96, 0x400000
    s_cbranch_scc1 pg_49

pgd_50:
    v_mov_b32 v5, 161564
    ds_write_b32 v5, v6

zok_48:
    s_and_b32 s63, s2, 15
    s_lshl_b32 s63, s63, 8
    s_add_u32 s63, s63, 16883712
    v_mov_b32 v3, s63

wp0_51:
    buffer_load_dword v13, v3, s[52:55], 0 offen sc1
    s_waitcnt vmcnt(0)
    v_readfirstlane_b32 s63, v13
    s_cmp_lg_u32 s63, 0
    s_cbranch_scc1 wp1_52
    s_sleep 8
    s_add_u32 s96, s96, 1
    s_cmp_lt_u32 s96, 0x400000
    s_cbranch_scc1 wp0_51

wp1_52:
    v_mov_b32 v13, 1
    ds_write_b32 v4, v13
    s_branch hgo_47

hoth_46:
    ds_read_b32 v13, v4
    s_waitcnt lgkmcnt(0)
    v_readfirstlane_b32 s63, v13
    s_cmp_ge_u32 s63, 1
    s_cbranch_scc1 hgo_47
    s_sleep 4
    s_add_u32 s96, s96, 1
    s_cmp_lt_u32 s96, 0x400000
    s_cbranch_scc1 hoth_46

hgo_47:
    buffer_load_dwordx4 v[160:163], v2, s[52:55], s69 offen offset:0 sc1
    buffer_load_dwordx4 v[164:167], v2, s[52:55], s69 offen offset:1024 sc1
    buffer_load_dwordx4 v[168:171], v2, s[52:55], s69 offen offset:2048 sc1
    buffer_load_dwordx4 v[172:175], v2, s[52:55], s69 offen offset:3072 sc1
    buffer_load_dwordx4 v[176:179], v12, s[52:55], s69 offen sc1
    s_add_u32 s69, s69, 5120
    s_cmp_ge_u32 s69, s74
    s_cselect_b32 s69, s72, s69
    buffer_load_dwordx4 v[180:183], v2, s[52:55], s69 offen offset:0 sc1
    buffer_load_dwordx4 v[184:187], v2, s[52:55], s69 offen offset:1024 sc1
    buffer_load_dwordx4 v[188:191], v2, s[52:55], s69 offen offset:2048 sc1
    buffer_load_dwordx4 v[192:195], v2, s[52:55], s69 offen offset:3072 sc1
    buffer_load_dwordx4 v[196:199], v12, s[52:55], s69 offen sc1
    s_add_u32 s69, s69, 5120
    s_cmp_ge_u32 s69, s74
    s_cselect_b32 s69, s72, s69
    buffer_load_dwordx4 v[200:203], v2, s[52:55], s69 offen offset:0 sc1
    buffer_load_dwordx4 v[204:207], v2, s[52:55], s69 offen offset:1024 sc1
    buffer_load_dwordx4 v[208:211], v2, s[52:55], s69 offen offset:2048 sc1
    buffer_load_dwordx4 v[212:215], v2, s[52:55], s69 offen offset:3072 sc1
    buffer_load_dwordx4 v[216:219], v12, s[52:55], s69 offen sc1
    s_add_u32 s69, s69, 5120
    s_cmp_ge_u32 s69, s74
    s_cselect_b32 s69, s72, s69
    buffer_load_dwordx4 v[220:223], v2, s[52:55], s69 offen offset:0 sc1
    buffer_load_dwordx4 v[224:227], v2, s[52:55], s69 offen offset:1024 sc1
    buffer_load_dwordx4 v[228:231], v2, s[52:55], s69 offen offset:2048 sc1
    buffer_load_dwordx4 v[232:235], v2, s[52:55], s69 offen offset:3072 sc1
    buffer_load_dwordx4 v[236:239], v12, s[52:55], s69 offen sc1
    s_add_u32 s69, s69, 5120
    s_cmp_ge_u32 s69, s74
    s_cselect_b32 s69, s72, s69
    s_cmp_lg_u32 s60, 0
    s_cbranch_scc1 g2w0_53
    s_lshr_b32 s63, s61, 1
    s_lshl_b32 s63, s63, 8
    s_add_u32 s63, s63, 16875520
    v_mov_b32 v3, s63

hp0_56:
    buffer_load_dword v13, v3, s[52:55], 0 offen sc1
    s_waitcnt vmcnt(0)
    v_readfirstlane_b32 s63, v13
    s_cmp_ge_u32 s63, 12
    s_cbranch_scc1 hp1_57
    s_sleep 2
    s_add_u32 s96, s96, 1
    s_cmp_lt_u32 s96, 0x400000
    s_cbranch_scc1 hp0_56

hp1_57:
    v_mov_b32 v4, 161536
    v_mov_b32 v13, 2
    ds_write_b32 v4, v13

g2w0_53:
    v_mov_b32 v4, 161536
g2w1_54:
    ds_read_b32 v13, v4
    s_waitcnt lgkmcnt(0)
    v_readfirstlane_b32 s63, v13
    s_cmp_ge_u32 s63, 2
    s_cbranch_scc1 g2w2_55
    s_sleep 2
    s_add_u32 s96, s96, 1
    s_cmp_lt_u32 s96, 0x400000
    s_cbranch_scc1 g2w1_54

g2w2_55:
    buffer_load_dwordx4 v[96:99], v8, s[52:55], s68 offen sc1
    buffer_load_dwordx4 v[100:103], v9, s[52:55], s68 offen sc1
    buffer_load_dwordx4 v[104:107], v10, s[52:55], s68 offen sc1
    buffer_load_dwordx4 v[108:111], v11, s[52:55], s68 offen sc1
    s_add_u32 s68, s68, 4096
    s_cmp_ge_u32 s68, s73
    s_cselect_b32 s68, s71, s68
    buffer_load_dwordx4 v[112:115], v8, s[52:55], s68 offen sc1
    buffer_load_dwordx4 v[116:119], v9, s[52:55], s68 offen sc1
    buffer_load_dwordx4 v[120:123], v10, s[52:55], s68 offen sc1
    buffer_load_dwordx4 v[124:127], v11, s[52:55], s68 offen sc1
    s_add_u32 s68, s68, 4096
    s_cmp_ge_u32 s68, s73
    s_cselect_b32 s68, s71, s68
    buffer_load_dwordx4 v[128:131], v8, s[52:55], s68 offen sc1
    buffer_load_dwordx4 v[132:135], v9, s[52:55], s68 offen sc1
    buffer_load_dwordx4 v[136:139], v10, s[52:55], s68 offen sc1
    buffer_load_dwordx4 v[140:143], v11, s[52:55], s68 offen sc1
    s_add_u32 s68, s68, 4096
    s_cmp_ge_u32 s68, s73
    s_cselect_b32 s68, s71, s68
    buffer_load_dwordx4 v[144:147], v8, s[52:55], s68 offen sc1
    buffer_load_dwordx4 v[148:151], v9, s[52:55], s68 offen sc1
    buffer_load_dwordx4 v[152:155], v10, s[52:55], s68 offen sc1
    buffer_load_dwordx4 v[156:159], v11, s[52:55], s68 offen sc1
    s_add_u32 s68, s68, 4096
    s_cmp_ge_u32 s68, s73
    s_cselect_b32 s68, s71, s68
    s_cmp_lt_u32 s2, 64
    s_cbranch_scc1 g2xg_59
    v_mov_b32 v4, 161552

g2xs_58:
    ds_read_b32 v13, v4
    s_waitcnt lgkmcnt(0)
    v_readfirstlane_b32 s63, v13
    s_add_u32 s96, s96, 1
    s_cmp_ge_u32 s96, 0x400000
    s_cselect_b32 s63, 8, s63
    s_cmp_lt_u32 s63, 8
    s_cbranch_scc1 g2xs_58

g2xg_59:
    s_mul_i32 s63, s61, 81920
    s_mul_i32 s64, s62, 160
    s_add_u32 s63, s63, s64
    s_lshl_b32 s65, s60, 10

    v_add_u32 v3, 0, v0
    v_mul_u32_u24 v4, 6554, v3
    v_lshrrev_b32 v4, 16, v4
    v_mul_u32_u24 v5, 10, v4
    v_sub_u32 v5, v3, v5
    v_mul_u32_u24 v4, 1280, v4
    v_lshl_add_u32 v4, v5, 4, v4
    s_add_u32 m0, s65, 65536
    s_nop 0
    buffer_load_dwordx4 v4, s[28:31], s63 offen lds

    v_add_u32 v3, 256, v0
    v_mul_u32_u24 v4, 6554, v3
    v_lshrrev_b32 v4, 16, v4
    v_mul_u32_u24 v5, 10, v4
    v_sub_u32 v5, v3, v5
    v_mul_u32_u24 v4, 1280, v4
    v_lshl_add_u32 v4, v5, 4, v4
    s_add_u32 m0, s65, 69632
    s_nop 0
    buffer_load_dwordx4 v4, s[28:31], s63 offen lds

    s_cmp_ge_u32 s60, 2
    s_cbranch_scc1 g2x_60
    v_add_u32 v3, 512, v0
    v_mul_u32_u24 v4, 6554, v3
    v_lshrrev_b32 v4, 16, v4
    v_mul_u32_u24 v5, 10, v4
    v_sub_u32 v5, v3, v5
    v_mul_u32_u24 v4, 1280, v4
    v_lshl_add_u32 v4, v5, 4, v4
    s_add_u32 m0, s65, 73728
    s_nop 0
    buffer_load_dwordx4 v4, s[28:31], s63 offen lds

g2x_60:
    v_and_b32 v3, 15, v1
    s_lshl_b32 s63, s61, 6
    s_lshl_b32 s64, s60, 4
    s_add_u32 s63, s63, s64
    v_add_u32 v3, s63, v3
    v_lshlrev_b32 v3, 3, v3
    s_mov_b32 s64, 16777216

    buffer_load_dwordx2 v[14:15], v3, s[52:55], s64 offen sc1
    s_waitcnt vmcnt(18)
    v_mfma_f32_16x16x32_bf16 v[16:19], v[160:163], v[96:99], v[16:19]
    s_waitcnt vmcnt(17)
    v_mfma_f32_16x16x32_bf16 v[36:39], v[160:163], v[100:103], v[36:39]
    s_waitcnt vmcnt(16)
    v_mfma_f32_16x16x32_bf16 v[56:59], v[160:163], v[104:107], v[56:59]
    s_waitcnt vmcnt(15)
    v_mfma_f32_16x16x32_bf16 v[76:79], v[160:163], v[108:111], v[76:79]
    v_mfma_f32_16x16x32_bf16 v[20:23], v[164:167], v[96:99], v[20:23]
    v_mfma_f32_16x16x32_bf16 v[40:43], v[164:167], v[100:103], v[40:43]
    v_mfma_f32_16x16x32_bf16 v[60:63], v[164:167], v[104:107], v[60:63]
    v_mfma_f32_16x16x32_bf16 v[80:83], v[164:167], v[108:111], v[80:83]
    v_mfma_f32_16x16x32_bf16 v[24:27], v[168:171], v[96:99], v[24:27]
    v_mfma_f32_16x16x32_bf16 v[44:47], v[168:171], v[100:103], v[44:47]
    v_mfma_f32_16x16x32_bf16 v[64:67], v[168:171], v[104:107], v[64:67]
    v_mfma_f32_16x16x32_bf16 v[84:87], v[168:171], v[108:111], v[84:87]
    v_mfma_f32_16x16x32_bf16 v[28:31], v[172:175], v[96:99], v[28:31]
    v_mfma_f32_16x16x32_bf16 v[48:51], v[172:175], v[100:103], v[48:51]
    v_mfma_f32_16x16x32_bf16 v[68:71], v[172:175], v[104:107], v[68:71]
    v_mfma_f32_16x16x32_bf16 v[88:91], v[172:175], v[108:111], v[88:91]
    v_mfma_f32_16x16x32_bf16 v[32:35], v[176:179], v[96:99], v[32:35]
    v_mfma_f32_16x16x32_bf16 v[52:55], v[176:179], v[100:103], v[52:55]
    v_mfma_f32_16x16x32_bf16 v[72:75], v[176:179], v[104:107], v[72:75]
    v_mfma_f32_16x16x32_bf16 v[92:95], v[176:179], v[108:111], v[92:95]
    buffer_load_dwordx4 v[96:99], v8, s[52:55], s68 offen sc1
    buffer_load_dwordx4 v[100:103], v9, s[52:55], s68 offen sc1
    buffer_load_dwordx4 v[104:107], v10, s[52:55], s68 offen sc1
    buffer_load_dwordx4 v[108:111], v11, s[52:55], s68 offen sc1
    s_add_u32 s68, s68, 4096
    s_cmp_ge_u32 s68, s73
    s_cselect_b32 s68, s71, s68
    buffer_load_dwordx4 v[160:163], v2, s[52:55], s69 offen offset:0 sc1
    buffer_load_dwordx4 v[164:167], v2, s[52:55], s69 offen offset:1024 sc1
    buffer_load_dwordx4 v[168:171], v2, s[52:55], s69 offen offset:2048 sc1
    buffer_load_dwordx4 v[172:175], v2, s[52:55], s69 offen offset:3072 sc1
    buffer_load_dwordx4 v[176:179], v12, s[52:55], s69 offen sc1
    s_add_u32 s69, s69, 5120
    s_cmp_ge_u32 s69, s74
    s_cselect_b32 s69, s72, s69
    s_waitcnt vmcnt(23)
    v_mfma_f32_16x16x32_bf16 v[16:19], v[180:183], v[112:115], v[16:19]
    s_waitcnt vmcnt(22)
    v_mfma_f32_16x16x32_bf16 v[36:39], v[180:183], v[116:119], v[36:39]
    s_waitcnt vmcnt(21)
    v_mfma_f32_16x16x32_bf16 v[56:59], v[180:183], v[120:123], v[56:59]
    s_waitcnt vmcnt(20)
    v_mfma_f32_16x16x32_bf16 v[76:79], v[180:183], v[124:127], v[76:79]
    v_mfma_f32_16x16x32_bf16 v[20:23], v[184:187], v[112:115], v[20:23]
    v_mfma_f32_16x16x32_bf16 v[40:43], v[184:187], v[116:119], v[40:43]
    v_mfma_f32_16x16x32_bf16 v[60:63], v[184:187], v[120:123], v[60:63]
    v_mfma_f32_16x16x32_bf16 v[80:83], v[184:187], v[124:127], v[80:83]
    v_mfma_f32_16x16x32_bf16 v[24:27], v[188:191], v[112:115], v[24:27]
    v_mfma_f32_16x16x32_bf16 v[44:47], v[188:191], v[116:119], v[44:47]
    v_mfma_f32_16x16x32_bf16 v[64:67], v[188:191], v[120:123], v[64:67]
    v_mfma_f32_16x16x32_bf16 v[84:87], v[188:191], v[124:127], v[84:87]
    v_mfma_f32_16x16x32_bf16 v[28:31], v[192:195], v[112:115], v[28:31]
    v_mfma_f32_16x16x32_bf16 v[48:51], v[192:195], v[116:119], v[48:51]
    v_mfma_f32_16x16x32_bf16 v[68:71], v[192:195], v[120:123], v[68:71]
    v_mfma_f32_16x16x32_bf16 v[88:91], v[192:195], v[124:127], v[88:91]
    v_mfma_f32_16x16x32_bf16 v[32:35], v[196:199], v[112:115], v[32:35]
    v_mfma_f32_16x16x32_bf16 v[52:55], v[196:199], v[116:119], v[52:55]
    v_mfma_f32_16x16x32_bf16 v[72:75], v[196:199], v[120:123], v[72:75]
    v_mfma_f32_16x16x32_bf16 v[92:95], v[196:199], v[124:127], v[92:95]
    buffer_load_dwordx4 v[112:115], v8, s[52:55], s68 offen sc1
    buffer_load_dwordx4 v[116:119], v9, s[52:55], s68 offen sc1
    buffer_load_dwordx4 v[120:123], v10, s[52:55], s68 offen sc1
    buffer_load_dwordx4 v[124:127], v11, s[52:55], s68 offen sc1
    s_add_u32 s68, s68, 4096
    s_cmp_ge_u32 s68, s73
    s_cselect_b32 s68, s71, s68
    buffer_load_dwordx4 v[180:183], v2, s[52:55], s69 offen offset:0 sc1
    buffer_load_dwordx4 v[184:187], v2, s[52:55], s69 offen offset:1024 sc1
    buffer_load_dwordx4 v[188:191], v2, s[52:55], s69 offen offset:2048 sc1
    buffer_load_dwordx4 v[192:195], v2, s[52:55], s69 offen offset:3072 sc1
    buffer_load_dwordx4 v[196:199], v12, s[52:55], s69 offen sc1
    s_add_u32 s69, s69, 5120
    s_cmp_ge_u32 s69, s74
    s_cselect_b32 s69, s72, s69
    s_waitcnt vmcnt(28)
    v_mfma_f32_16x16x32_bf16 v[16:19], v[200:203], v[128:131], v[16:19]
    s_waitcnt vmcnt(27)
    v_mfma_f32_16x16x32_bf16 v[36:39], v[200:203], v[132:135], v[36:39]
    s_waitcnt vmcnt(26)
    v_mfma_f32_16x16x32_bf16 v[56:59], v[200:203], v[136:139], v[56:59]
    s_waitcnt vmcnt(25)
    v_mfma_f32_16x16x32_bf16 v[76:79], v[200:203], v[140:143], v[76:79]
    v_mfma_f32_16x16x32_bf16 v[20:23], v[204:207], v[128:131], v[20:23]
    v_mfma_f32_16x16x32_bf16 v[40:43], v[204:207], v[132:135], v[40:43]
    v_mfma_f32_16x16x32_bf16 v[60:63], v[204:207], v[136:139], v[60:63]
    v_mfma_f32_16x16x32_bf16 v[80:83], v[204:207], v[140:143], v[80:83]
    v_mfma_f32_16x16x32_bf16 v[24:27], v[208:211], v[128:131], v[24:27]
    v_mfma_f32_16x16x32_bf16 v[44:47], v[208:211], v[132:135], v[44:47]
    v_mfma_f32_16x16x32_bf16 v[64:67], v[208:211], v[136:139], v[64:67]
    v_mfma_f32_16x16x32_bf16 v[84:87], v[208:211], v[140:143], v[84:87]
    v_mfma_f32_16x16x32_bf16 v[28:31], v[212:215], v[128:131], v[28:31]
    v_mfma_f32_16x16x32_bf16 v[48:51], v[212:215], v[132:135], v[48:51]
    v_mfma_f32_16x16x32_bf16 v[68:71], v[212:215], v[136:139], v[68:71]
    v_mfma_f32_16x16x32_bf16 v[88:91], v[212:215], v[140:143], v[88:91]
    v_mfma_f32_16x16x32_bf16 v[32:35], v[216:219], v[128:131], v[32:35]
    v_mfma_f32_16x16x32_bf16 v[52:55], v[216:219], v[132:135], v[52:55]
    v_mfma_f32_16x16x32_bf16 v[72:75], v[216:219], v[136:139], v[72:75]
    v_mfma_f32_16x16x32_bf16 v[92:95], v[216:219], v[140:143], v[92:95]
    buffer_load_dwordx4 v[128:131], v8, s[52:55], s68 offen sc1
    buffer_load_dwordx4 v[132:135], v9, s[52:55], s68 offen sc1
    buffer_load_dwordx4 v[136:139], v10, s[52:55], s68 offen sc1
    buffer_load_dwordx4 v[140:143], v11, s[52:55], s68 offen sc1
    s_add_u32 s68, s68, 4096
    s_cmp_ge_u32 s68, s73
    s_cselect_b32 s68, s71, s68
    buffer_load_dwordx4 v[200:203], v2, s[52:55], s69 offen offset:0 sc1
    buffer_load_dwordx4 v[204:207], v2, s[52:55], s69 offen offset:1024 sc1
    buffer_load_dwordx4 v[208:211], v2, s[52:55], s69 offen offset:2048 sc1
    buffer_load_dwordx4 v[212:215], v2, s[52:55], s69 offen offset:3072 sc1
    buffer_load_dwordx4 v[216:219], v12, s[52:55], s69 offen sc1
    s_add_u32 s69, s69, 5120
    s_cmp_ge_u32 s69, s74
    s_cselect_b32 s69, s72, s69
    s_waitcnt vmcnt(33)
    v_mfma_f32_16x16x32_bf16 v[16:19], v[220:223], v[144:147], v[16:19]
    s_waitcnt vmcnt(32)
    v_mfma_f32_16x16x32_bf16 v[36:39], v[220:223], v[148:151], v[36:39]
    s_waitcnt vmcnt(31)
    v_mfma_f32_16x16x32_bf16 v[56:59], v[220:223], v[152:155], v[56:59]
    s_waitcnt vmcnt(30)
    v_mfma_f32_16x16x32_bf16 v[76:79], v[220:223], v[156:159], v[76:79]
    v_mfma_f32_16x16x32_bf16 v[20:23], v[224:227], v[144:147], v[20:23]
    v_mfma_f32_16x16x32_bf16 v[40:43], v[224:227], v[148:151], v[40:43]
    v_mfma_f32_16x16x32_bf16 v[60:63], v[224:227], v[152:155], v[60:63]
    v_mfma_f32_16x16x32_bf16 v[80:83], v[224:227], v[156:159], v[80:83]
    v_mfma_f32_16x16x32_bf16 v[24:27], v[228:231], v[144:147], v[24:27]
    v_mfma_f32_16x16x32_bf16 v[44:47], v[228:231], v[148:151], v[44:47]
    v_mfma_f32_16x16x32_bf16 v[64:67], v[228:231], v[152:155], v[64:67]
    v_mfma_f32_16x16x32_bf16 v[84:87], v[228:231], v[156:159], v[84:87]
    v_mfma_f32_16x16x32_bf16 v[28:31], v[232:235], v[144:147], v[28:31]
    v_mfma_f32_16x16x32_bf16 v[48:51], v[232:235], v[148:151], v[48:51]
    v_mfma_f32_16x16x32_bf16 v[68:71], v[232:235], v[152:155], v[68:71]
    v_mfma_f32_16x16x32_bf16 v[88:91], v[232:235], v[156:159], v[88:91]
    v_mfma_f32_16x16x32_bf16 v[32:35], v[236:239], v[144:147], v[32:35]
    v_mfma_f32_16x16x32_bf16 v[52:55], v[236:239], v[148:151], v[52:55]
    v_mfma_f32_16x16x32_bf16 v[72:75], v[236:239], v[152:155], v[72:75]
    v_mfma_f32_16x16x32_bf16 v[92:95], v[236:239], v[156:159], v[92:95]
    buffer_load_dwordx4 v[144:147], v8, s[52:55], s68 offen sc1
    buffer_load_dwordx4 v[148:151], v9, s[52:55], s68 offen sc1
    buffer_load_dwordx4 v[152:155], v10, s[52:55], s68 offen sc1
    buffer_load_dwordx4 v[156:159], v11, s[52:55], s68 offen sc1
    s_add_u32 s68, s68, 4096
    s_cmp_ge_u32 s68, s73
    s_cselect_b32 s68, s71, s68
    buffer_load_dwordx4 v[220:223], v2, s[52:55], s69 offen offset:0 sc1
    buffer_load_dwordx4 v[224:227], v2, s[52:55], s69 offen offset:1024 sc1
    buffer_load_dwordx4 v[228:231], v2, s[52:55], s69 offen offset:2048 sc1
    buffer_load_dwordx4 v[232:235], v2, s[52:55], s69 offen offset:3072 sc1
    buffer_load_dwordx4 v[236:239], v12, s[52:55], s69 offen sc1
    s_add_u32 s69, s69, 5120
    s_cmp_ge_u32 s69, s74
    s_cselect_b32 s69, s72, s69
    s_waitcnt vmcnt(31)
    v_mfma_f32_16x16x32_bf16 v[16:19], v[160:163], v[96:99], v[16:19]
    v_mfma_f32_16x16x32_bf16 v[36:39], v[160:163], v[100:103], v[36:39]
    v_mfma_f32_16x16x32_bf16 v[56:59], v[160:163], v[104:107], v[56:59]
    v_mfma_f32_16x16x32_bf16 v[76:79], v[160:163], v[108:111], v[76:79]
    s_waitcnt vmcnt(30)
    v_mfma_f32_16x16x32_bf16 v[20:23], v[164:167], v[96:99], v[20:23]
    v_mfma_f32_16x16x32_bf16 v[40:43], v[164:167], v[100:103], v[40:43]
    v_mfma_f32_16x16x32_bf16 v[60:63], v[164:167], v[104:107], v[60:63]
    v_mfma_f32_16x16x32_bf16 v[80:83], v[164:167], v[108:111], v[80:83]
    s_waitcnt vmcnt(29)
    v_mfma_f32_16x16x32_bf16 v[24:27], v[168:171], v[96:99], v[24:27]
    v_mfma_f32_16x16x32_bf16 v[44:47], v[168:171], v[100:103], v[44:47]
    v_mfma_f32_16x16x32_bf16 v[64:67], v[168:171], v[104:107], v[64:67]
    v_mfma_f32_16x16x32_bf16 v[84:87], v[168:171], v[108:111], v[84:87]
    s_waitcnt vmcnt(28)
    v_mfma_f32_16x16x32_bf16 v[28:31], v[172:175], v[96:99], v[28:31]
    v_mfma_f32_16x16x32_bf16 v[48:51], v[172:175], v[100:103], v[48:51]
    v_mfma_f32_16x16x32_bf16 v[68:71], v[172:175], v[104:107], v[68:71]
    v_mfma_f32_16x16x32_bf16 v[88:91], v[172:175], v[108:111], v[88:91]
    s_waitcnt vmcnt(27)
    v_mfma_f32_16x16x32_bf16 v[32:35], v[176:179], v[96:99], v[32:35]
    v_mfma_f32_16x16x32_bf16 v[52:55], v[176:179], v[100:103], v[52:55]
    v_mfma_f32_16x16x32_bf16 v[72:75], v[176:179], v[104:107], v[72:75]
    v_mfma_f32_16x16x32_bf16 v[92:95], v[176:179], v[108:111], v[92:95]
    buffer_load_dwordx4 v[96:99], v8, s[52:55], s68 offen sc1
    buffer_load_dwordx4 v[100:103], v9, s[52:55], s68 offen sc1
    buffer_load_dwordx4 v[104:107], v10, s[52:55], s68 offen sc1
    buffer_load_dwordx4 v[108:111], v11, s[52:55], s68 offen sc1
    s_add_u32 s68, s68, 4096
    s_cmp_ge_u32 s68, s73
    s_cselect_b32 s68, s71, s68
    buffer_load_dwordx4 v[160:163], v2, s[52:55], s69 offen offset:0 sc1
    buffer_load_dwordx4 v[164:167], v2, s[52:55], s69 offen offset:1024 sc1
    buffer_load_dwordx4 v[168:171], v2, s[52:55], s69 offen offset:2048 sc1
    buffer_load_dwordx4 v[172:175], v2, s[52:55], s69 offen offset:3072 sc1
    buffer_load_dwordx4 v[176:179], v12, s[52:55], s69 offen sc1
    s_add_u32 s69, s69, 5120
    s_cmp_ge_u32 s69, s74
    s_cselect_b32 s69, s72, s69
    s_waitcnt vmcnt(31)
    v_mfma_f32_16x16x32_bf16 v[16:19], v[180:183], v[112:115], v[16:19]
    v_mfma_f32_16x16x32_bf16 v[36:39], v[180:183], v[116:119], v[36:39]
    v_mfma_f32_16x16x32_bf16 v[56:59], v[180:183], v[120:123], v[56:59]
    v_mfma_f32_16x16x32_bf16 v[76:79], v[180:183], v[124:127], v[76:79]
    s_waitcnt vmcnt(30)
    v_mfma_f32_16x16x32_bf16 v[20:23], v[184:187], v[112:115], v[20:23]
    v_mfma_f32_16x16x32_bf16 v[40:43], v[184:187], v[116:119], v[40:43]
    v_mfma_f32_16x16x32_bf16 v[60:63], v[184:187], v[120:123], v[60:63]
    v_mfma_f32_16x16x32_bf16 v[80:83], v[184:187], v[124:127], v[80:83]
    s_waitcnt vmcnt(29)
    v_mfma_f32_16x16x32_bf16 v[24:27], v[188:191], v[112:115], v[24:27]
    v_mfma_f32_16x16x32_bf16 v[44:47], v[188:191], v[116:119], v[44:47]
    v_mfma_f32_16x16x32_bf16 v[64:67], v[188:191], v[120:123], v[64:67]
    v_mfma_f32_16x16x32_bf16 v[84:87], v[188:191], v[124:127], v[84:87]
    s_waitcnt vmcnt(28)
    v_mfma_f32_16x16x32_bf16 v[28:31], v[192:195], v[112:115], v[28:31]
    v_mfma_f32_16x16x32_bf16 v[48:51], v[192:195], v[116:119], v[48:51]
    v_mfma_f32_16x16x32_bf16 v[68:71], v[192:195], v[120:123], v[68:71]
    v_mfma_f32_16x16x32_bf16 v[88:91], v[192:195], v[124:127], v[88:91]
    s_waitcnt vmcnt(27)
    v_mfma_f32_16x16x32_bf16 v[32:35], v[196:199], v[112:115], v[32:35]
    v_mfma_f32_16x16x32_bf16 v[52:55], v[196:199], v[116:119], v[52:55]
    v_mfma_f32_16x16x32_bf16 v[72:75], v[196:199], v[120:123], v[72:75]
    v_mfma_f32_16x16x32_bf16 v[92:95], v[196:199], v[124:127], v[92:95]
    buffer_load_dwordx4 v[112:115], v8, s[52:55], s68 offen sc1
    buffer_load_dwordx4 v[116:119], v9, s[52:55], s68 offen sc1
    buffer_load_dwordx4 v[120:123], v10, s[52:55], s68 offen sc1
    buffer_load_dwordx4 v[124:127], v11, s[52:55], s68 offen sc1
    s_add_u32 s68, s68, 4096
    s_cmp_ge_u32 s68, s73
    s_cselect_b32 s68, s71, s68
    buffer_load_dwordx4 v[180:183], v2, s[52:55], s69 offen offset:0 sc1
    buffer_load_dwordx4 v[184:187], v2, s[52:55], s69 offen offset:1024 sc1
    buffer_load_dwordx4 v[188:191], v2, s[52:55], s69 offen offset:2048 sc1
    buffer_load_dwordx4 v[192:195], v2, s[52:55], s69 offen offset:3072 sc1
    buffer_load_dwordx4 v[196:199], v12, s[52:55], s69 offen sc1
    s_add_u32 s69, s69, 5120
    s_cmp_ge_u32 s69, s74
    s_cselect_b32 s69, s72, s69
    s_waitcnt vmcnt(31)
    v_mfma_f32_16x16x32_bf16 v[16:19], v[200:203], v[128:131], v[16:19]
    v_mfma_f32_16x16x32_bf16 v[36:39], v[200:203], v[132:135], v[36:39]
    v_mfma_f32_16x16x32_bf16 v[56:59], v[200:203], v[136:139], v[56:59]
    v_mfma_f32_16x16x32_bf16 v[76:79], v[200:203], v[140:143], v[76:79]
    s_waitcnt vmcnt(30)
    v_mfma_f32_16x16x32_bf16 v[20:23], v[204:207], v[128:131], v[20:23]
    v_mfma_f32_16x16x32_bf16 v[40:43], v[204:207], v[132:135], v[40:43]
    v_mfma_f32_16x16x32_bf16 v[60:63], v[204:207], v[136:139], v[60:63]
    v_mfma_f32_16x16x32_bf16 v[80:83], v[204:207], v[140:143], v[80:83]
    s_waitcnt vmcnt(29)
    v_mfma_f32_16x16x32_bf16 v[24:27], v[208:211], v[128:131], v[24:27]
    v_mfma_f32_16x16x32_bf16 v[44:47], v[208:211], v[132:135], v[44:47]
    v_mfma_f32_16x16x32_bf16 v[64:67], v[208:211], v[136:139], v[64:67]
    v_mfma_f32_16x16x32_bf16 v[84:87], v[208:211], v[140:143], v[84:87]
    s_waitcnt vmcnt(28)
    v_mfma_f32_16x16x32_bf16 v[28:31], v[212:215], v[128:131], v[28:31]
    v_mfma_f32_16x16x32_bf16 v[48:51], v[212:215], v[132:135], v[48:51]
    v_mfma_f32_16x16x32_bf16 v[68:71], v[212:215], v[136:139], v[68:71]
    v_mfma_f32_16x16x32_bf16 v[88:91], v[212:215], v[140:143], v[88:91]
    s_waitcnt vmcnt(27)
    v_mfma_f32_16x16x32_bf16 v[32:35], v[216:219], v[128:131], v[32:35]
    v_mfma_f32_16x16x32_bf16 v[52:55], v[216:219], v[132:135], v[52:55]
    v_mfma_f32_16x16x32_bf16 v[72:75], v[216:219], v[136:139], v[72:75]
    v_mfma_f32_16x16x32_bf16 v[92:95], v[216:219], v[140:143], v[92:95]
    buffer_load_dwordx4 v[128:131], v8, s[52:55], s68 offen sc1
    buffer_load_dwordx4 v[132:135], v9, s[52:55], s68 offen sc1
    buffer_load_dwordx4 v[136:139], v10, s[52:55], s68 offen sc1
    buffer_load_dwordx4 v[140:143], v11, s[52:55], s68 offen sc1
    s_add_u32 s68, s68, 4096
    s_cmp_ge_u32 s68, s73
    s_cselect_b32 s68, s71, s68
    buffer_load_dwordx4 v[200:203], v2, s[52:55], s69 offen offset:0 sc1
    buffer_load_dwordx4 v[204:207], v2, s[52:55], s69 offen offset:1024 sc1
    buffer_load_dwordx4 v[208:211], v2, s[52:55], s69 offen offset:2048 sc1
    buffer_load_dwordx4 v[212:215], v2, s[52:55], s69 offen offset:3072 sc1
    buffer_load_dwordx4 v[216:219], v12, s[52:55], s69 offen sc1
    s_add_u32 s69, s69, 5120
    s_cmp_ge_u32 s69, s74
    s_cselect_b32 s69, s72, s69
    s_waitcnt vmcnt(31)
    v_mfma_f32_16x16x32_bf16 v[16:19], v[220:223], v[144:147], v[16:19]
    v_mfma_f32_16x16x32_bf16 v[36:39], v[220:223], v[148:151], v[36:39]
    v_mfma_f32_16x16x32_bf16 v[56:59], v[220:223], v[152:155], v[56:59]
    v_mfma_f32_16x16x32_bf16 v[76:79], v[220:223], v[156:159], v[76:79]
    s_waitcnt vmcnt(30)
    v_mfma_f32_16x16x32_bf16 v[20:23], v[224:227], v[144:147], v[20:23]
    v_mfma_f32_16x16x32_bf16 v[40:43], v[224:227], v[148:151], v[40:43]
    v_mfma_f32_16x16x32_bf16 v[60:63], v[224:227], v[152:155], v[60:63]
    v_mfma_f32_16x16x32_bf16 v[80:83], v[224:227], v[156:159], v[80:83]
    s_waitcnt vmcnt(29)
    v_mfma_f32_16x16x32_bf16 v[24:27], v[228:231], v[144:147], v[24:27]
    v_mfma_f32_16x16x32_bf16 v[44:47], v[228:231], v[148:151], v[44:47]
    v_mfma_f32_16x16x32_bf16 v[64:67], v[228:231], v[152:155], v[64:67]
    v_mfma_f32_16x16x32_bf16 v[84:87], v[228:231], v[156:159], v[84:87]
    s_waitcnt vmcnt(28)
    v_mfma_f32_16x16x32_bf16 v[28:31], v[232:235], v[144:147], v[28:31]
    v_mfma_f32_16x16x32_bf16 v[48:51], v[232:235], v[148:151], v[48:51]
    v_mfma_f32_16x16x32_bf16 v[68:71], v[232:235], v[152:155], v[68:71]
    v_mfma_f32_16x16x32_bf16 v[88:91], v[232:235], v[156:159], v[88:91]
    s_waitcnt vmcnt(27)
    v_mfma_f32_16x16x32_bf16 v[32:35], v[236:239], v[144:147], v[32:35]
    v_mfma_f32_16x16x32_bf16 v[52:55], v[236:239], v[148:151], v[52:55]
    v_mfma_f32_16x16x32_bf16 v[72:75], v[236:239], v[152:155], v[72:75]
    v_mfma_f32_16x16x32_bf16 v[92:95], v[236:239], v[156:159], v[92:95]
    buffer_load_dwordx4 v[144:147], v8, s[52:55], s68 offen sc1
    buffer_load_dwordx4 v[148:151], v9, s[52:55], s68 offen sc1
    buffer_load_dwordx4 v[152:155], v10, s[52:55], s68 offen sc1
    buffer_load_dwordx4 v[156:159], v11, s[52:55], s68 offen sc1
    s_add_u32 s68, s68, 4096
    s_cmp_ge_u32 s68, s73
    s_cselect_b32 s68, s71, s68
    buffer_load_dwordx4 v[220:223], v2, s[52:55], s69 offen offset:0 sc1
    buffer_load_dwordx4 v[224:227], v2, s[52:55], s69 offen offset:1024 sc1
    buffer_load_dwordx4 v[228:231], v2, s[52:55], s69 offen offset:2048 sc1
    buffer_load_dwordx4 v[232:235], v2, s[52:55], s69 offen offset:3072 sc1
    buffer_load_dwordx4 v[236:239], v12, s[52:55], s69 offen sc1
    s_add_u32 s69, s69, 5120
    s_cmp_ge_u32 s69, s74
    s_cselect_b32 s69, s72, s69
    s_waitcnt vmcnt(31)
    v_mfma_f32_16x16x32_bf16 v[16:19], v[160:163], v[96:99], v[16:19]
    v_mfma_f32_16x16x32_bf16 v[36:39], v[160:163], v[100:103], v[36:39]
    v_mfma_f32_16x16x32_bf16 v[56:59], v[160:163], v[104:107], v[56:59]
    v_mfma_f32_16x16x32_bf16 v[76:79], v[160:163], v[108:111], v[76:79]
    s_waitcnt vmcnt(30)
    v_mfma_f32_16x16x32_bf16 v[20:23], v[164:167], v[96:99], v[20:23]
    v_mfma_f32_16x16x32_bf16 v[40:43], v[164:167], v[100:103], v[40:43]
    v_mfma_f32_16x16x32_bf16 v[60:63], v[164:167], v[104:107], v[60:63]
    v_mfma_f32_16x16x32_bf16 v[80:83], v[164:167], v[108:111], v[80:83]
    s_waitcnt vmcnt(29)
    v_mfma_f32_16x16x32_bf16 v[24:27], v[168:171], v[96:99], v[24:27]
    v_mfma_f32_16x16x32_bf16 v[44:47], v[168:171], v[100:103], v[44:47]
    v_mfma_f32_16x16x32_bf16 v[64:67], v[168:171], v[104:107], v[64:67]
    v_mfma_f32_16x16x32_bf16 v[84:87], v[168:171], v[108:111], v[84:87]
    s_waitcnt vmcnt(28)
    v_mfma_f32_16x16x32_bf16 v[28:31], v[172:175], v[96:99], v[28:31]
    v_mfma_f32_16x16x32_bf16 v[48:51], v[172:175], v[100:103], v[48:51]
    v_mfma_f32_16x16x32_bf16 v[68:71], v[172:175], v[104:107], v[68:71]
    v_mfma_f32_16x16x32_bf16 v[88:91], v[172:175], v[108:111], v[88:91]
    s_waitcnt vmcnt(27)
    v_mfma_f32_16x16x32_bf16 v[32:35], v[176:179], v[96:99], v[32:35]
    v_mfma_f32_16x16x32_bf16 v[52:55], v[176:179], v[100:103], v[52:55]
    v_mfma_f32_16x16x32_bf16 v[72:75], v[176:179], v[104:107], v[72:75]
    v_mfma_f32_16x16x32_bf16 v[92:95], v[176:179], v[108:111], v[92:95]
    buffer_load_dwordx4 v[96:99], v8, s[52:55], s68 offen sc1
    buffer_load_dwordx4 v[100:103], v9, s[52:55], s68 offen sc1
    buffer_load_dwordx4 v[104:107], v10, s[52:55], s68 offen sc1
    buffer_load_dwordx4 v[108:111], v11, s[52:55], s68 offen sc1
    s_add_u32 s68, s68, 4096
    s_cmp_ge_u32 s68, s73
    s_cselect_b32 s68, s71, s68
    buffer_load_dwordx4 v[160:163], v2, s[52:55], s69 offen offset:0 sc1
    buffer_load_dwordx4 v[164:167], v2, s[52:55], s69 offen offset:1024 sc1
    buffer_load_dwordx4 v[168:171], v2, s[52:55], s69 offen offset:2048 sc1
    buffer_load_dwordx4 v[172:175], v2, s[52:55], s69 offen offset:3072 sc1
    buffer_load_dwordx4 v[176:179], v12, s[52:55], s69 offen sc1
    s_add_u32 s69, s69, 5120
    s_cmp_ge_u32 s69, s74
    s_cselect_b32 s69, s72, s69
    s_waitcnt vmcnt(31)
    v_mfma_f32_16x16x32_bf16 v[16:19], v[180:183], v[112:115], v[16:19]
    v_mfma_f32_16x16x32_bf16 v[36:39], v[180:183], v[116:119], v[36:39]
    v_mfma_f32_16x16x32_bf16 v[56:59], v[180:183], v[120:123], v[56:59]
    v_mfma_f32_16x16x32_bf16 v[76:79], v[180:183], v[124:127], v[76:79]
    s_waitcnt vmcnt(30)
    v_mfma_f32_16x16x32_bf16 v[20:23], v[184:187], v[112:115], v[20:23]
    v_mfma_f32_16x16x32_bf16 v[40:43], v[184:187], v[116:119], v[40:43]
    v_mfma_f32_16x16x32_bf16 v[60:63], v[184:187], v[120:123], v[60:63]
    v_mfma_f32_16x16x32_bf16 v[80:83], v[184:187], v[124:127], v[80:83]
    s_waitcnt vmcnt(29)
    v_mfma_f32_16x16x32_bf16 v[24:27], v[188:191], v[112:115], v[24:27]
    v_mfma_f32_16x16x32_bf16 v[44:47], v[188:191], v[116:119], v[44:47]
    v_mfma_f32_16x16x32_bf16 v[64:67], v[188:191], v[120:123], v[64:67]
    v_mfma_f32_16x16x32_bf16 v[84:87], v[188:191], v[124:127], v[84:87]
    s_waitcnt vmcnt(28)
    v_mfma_f32_16x16x32_bf16 v[28:31], v[192:195], v[112:115], v[28:31]
    v_mfma_f32_16x16x32_bf16 v[48:51], v[192:195], v[116:119], v[48:51]
    v_mfma_f32_16x16x32_bf16 v[68:71], v[192:195], v[120:123], v[68:71]
    v_mfma_f32_16x16x32_bf16 v[88:91], v[192:195], v[124:127], v[88:91]
    s_waitcnt vmcnt(27)
    v_mfma_f32_16x16x32_bf16 v[32:35], v[196:199], v[112:115], v[32:35]
    v_mfma_f32_16x16x32_bf16 v[52:55], v[196:199], v[116:119], v[52:55]
    v_mfma_f32_16x16x32_bf16 v[72:75], v[196:199], v[120:123], v[72:75]
    v_mfma_f32_16x16x32_bf16 v[92:95], v[196:199], v[124:127], v[92:95]
    buffer_load_dwordx4 v[112:115], v8, s[52:55], s68 offen sc1
    buffer_load_dwordx4 v[116:119], v9, s[52:55], s68 offen sc1
    buffer_load_dwordx4 v[120:123], v10, s[52:55], s68 offen sc1
    buffer_load_dwordx4 v[124:127], v11, s[52:55], s68 offen sc1
    s_add_u32 s68, s68, 4096
    s_cmp_ge_u32 s68, s73
    s_cselect_b32 s68, s71, s68
    buffer_load_dwordx4 v[180:183], v2, s[52:55], s69 offen offset:0 sc1
    buffer_load_dwordx4 v[184:187], v2, s[52:55], s69 offen offset:1024 sc1
    buffer_load_dwordx4 v[188:191], v2, s[52:55], s69 offen offset:2048 sc1
    buffer_load_dwordx4 v[192:195], v2, s[52:55], s69 offen offset:3072 sc1
    buffer_load_dwordx4 v[196:199], v12, s[52:55], s69 offen sc1
    s_add_u32 s69, s69, 5120
    s_cmp_ge_u32 s69, s74
    s_cselect_b32 s69, s72, s69
    s_waitcnt vmcnt(31)
    v_mfma_f32_16x16x32_bf16 v[16:19], v[200:203], v[128:131], v[16:19]
    v_mfma_f32_16x16x32_bf16 v[36:39], v[200:203], v[132:135], v[36:39]
    v_mfma_f32_16x16x32_bf16 v[56:59], v[200:203], v[136:139], v[56:59]
    v_mfma_f32_16x16x32_bf16 v[76:79], v[200:203], v[140:143], v[76:79]
    s_waitcnt vmcnt(30)
    v_mfma_f32_16x16x32_bf16 v[20:23], v[204:207], v[128:131], v[20:23]
    v_mfma_f32_16x16x32_bf16 v[40:43], v[204:207], v[132:135], v[40:43]
    v_mfma_f32_16x16x32_bf16 v[60:63], v[204:207], v[136:139], v[60:63]
    v_mfma_f32_16x16x32_bf16 v[80:83], v[204:207], v[140:143], v[80:83]
    s_waitcnt vmcnt(29)
    v_mfma_f32_16x16x32_bf16 v[24:27], v[208:211], v[128:131], v[24:27]
    v_mfma_f32_16x16x32_bf16 v[44:47], v[208:211], v[132:135], v[44:47]
    v_mfma_f32_16x16x32_bf16 v[64:67], v[208:211], v[136:139], v[64:67]
    v_mfma_f32_16x16x32_bf16 v[84:87], v[208:211], v[140:143], v[84:87]
    s_waitcnt vmcnt(28)
    v_mfma_f32_16x16x32_bf16 v[28:31], v[212:215], v[128:131], v[28:31]
    v_mfma_f32_16x16x32_bf16 v[48:51], v[212:215], v[132:135], v[48:51]
    v_mfma_f32_16x16x32_bf16 v[68:71], v[212:215], v[136:139], v[68:71]
    v_mfma_f32_16x16x32_bf16 v[88:91], v[212:215], v[140:143], v[88:91]
    s_waitcnt vmcnt(27)
    v_mfma_f32_16x16x32_bf16 v[32:35], v[216:219], v[128:131], v[32:35]
    v_mfma_f32_16x16x32_bf16 v[52:55], v[216:219], v[132:135], v[52:55]
    v_mfma_f32_16x16x32_bf16 v[72:75], v[216:219], v[136:139], v[72:75]
    v_mfma_f32_16x16x32_bf16 v[92:95], v[216:219], v[140:143], v[92:95]
    s_waitcnt vmcnt(22)
    v_mfma_f32_16x16x32_bf16 v[16:19], v[220:223], v[144:147], v[16:19]
    v_mfma_f32_16x16x32_bf16 v[36:39], v[220:223], v[148:151], v[36:39]
    v_mfma_f32_16x16x32_bf16 v[56:59], v[220:223], v[152:155], v[56:59]
    v_mfma_f32_16x16x32_bf16 v[76:79], v[220:223], v[156:159], v[76:79]
    s_waitcnt vmcnt(21)
    v_mfma_f32_16x16x32_bf16 v[20:23], v[224:227], v[144:147], v[20:23]
    v_mfma_f32_16x16x32_bf16 v[40:43], v[224:227], v[148:151], v[40:43]
    v_mfma_f32_16x16x32_bf16 v[60:63], v[224:227], v[152:155], v[60:63]
    v_mfma_f32_16x16x32_bf16 v[80:83], v[224:227], v[156:159], v[80:83]
    s_waitcnt vmcnt(20)
    v_mfma_f32_16x16x32_bf16 v[24:27], v[228:231], v[144:147], v[24:27]
    v_mfma_f32_16x16x32_bf16 v[44:47], v[228:231], v[148:151], v[44:47]
    v_mfma_f32_16x16x32_bf16 v[64:67], v[228:231], v[152:155], v[64:67]
    v_mfma_f32_16x16x32_bf16 v[84:87], v[228:231], v[156:159], v[84:87]
    s_waitcnt vmcnt(19)
    v_mfma_f32_16x16x32_bf16 v[28:31], v[232:235], v[144:147], v[28:31]
    v_mfma_f32_16x16x32_bf16 v[48:51], v[232:235], v[148:151], v[48:51]
    v_mfma_f32_16x16x32_bf16 v[68:71], v[232:235], v[152:155], v[68:71]
    v_mfma_f32_16x16x32_bf16 v[88:91], v[232:235], v[156:159], v[88:91]
    s_waitcnt vmcnt(18)
    v_mfma_f32_16x16x32_bf16 v[32:35], v[236:239], v[144:147], v[32:35]
    v_mfma_f32_16x16x32_bf16 v[52:55], v[236:239], v[148:151], v[52:55]
    v_mfma_f32_16x16x32_bf16 v[72:75], v[236:239], v[152:155], v[72:75]
    v_mfma_f32_16x16x32_bf16 v[92:95], v[236:239], v[156:159], v[92:95]
    s_waitcnt vmcnt(13)
    v_mfma_f32_16x16x32_bf16 v[16:19], v[160:163], v[96:99], v[16:19]
    v_mfma_f32_16x16x32_bf16 v[36:39], v[160:163], v[100:103], v[36:39]
    v_mfma_f32_16x16x32_bf16 v[56:59], v[160:163], v[104:107], v[56:59]
    v_mfma_f32_16x16x32_bf16 v[76:79], v[160:163], v[108:111], v[76:79]
    s_waitcnt vmcnt(12)
    v_mfma_f32_16x16x32_bf16 v[20:23], v[164:167], v[96:99], v[20:23]
    v_mfma_f32_16x16x32_bf16 v[40:43], v[164:167], v[100:103], v[40:43]
    v_mfma_f32_16x16x32_bf16 v[60:63], v[164:167], v[104:107], v[60:63]
    v_mfma_f32_16x16x32_bf16 v[80:83], v[164:167], v[108:111], v[80:83]
    s_waitcnt vmcnt(11)
    v_mfma_f32_16x16x32_bf16 v[24:27], v[168:171], v[96:99], v[24:27]
    v_mfma_f32_16x16x32_bf16 v[44:47], v[168:171], v[100:103], v[44:47]
    v_mfma_f32_16x16x32_bf16 v[64:67], v[168:171], v[104:107], v[64:67]
    v_mfma_f32_16x16x32_bf16 v[84:87], v[168:171], v[108:111], v[84:87]
    s_waitcnt vmcnt(10)
    v_mfma_f32_16x16x32_bf16 v[28:31], v[172:175], v[96:99], v[28:31]
    v_mfma_f32_16x16x32_bf16 v[48:51], v[172:175], v[100:103], v[48:51]
    v_mfma_f32_16x16x32_bf16 v[68:71], v[172:175], v[104:107], v[68:71]
    v_mfma_f32_16x16x32_bf16 v[88:91], v[172:175], v[108:111], v[88:91]
    s_waitcnt vmcnt(9)
    v_mfma_f32_16x16x32_bf16 v[32:35], v[176:179], v[96:99], v[32:35]
    v_mfma_f32_16x16x32_bf16 v[52:55], v[176:179], v[100:103], v[52:55]
    v_mfma_f32_16x16x32_bf16 v[72:75], v[176:179], v[104:107], v[72:75]
    v_mfma_f32_16x16x32_bf16 v[92:95], v[176:179], v[108:111], v[92:95]
    s_cmp_ge_u32 s60, 2
    s_cbranch_scc1 g2skip_61
    s_waitcnt vmcnt(4)
    v_mfma_f32_16x16x32_bf16 v[16:19], v[180:183], v[112:115], v[16:19]
    v_mfma_f32_16x16x32_bf16 v[36:39], v[180:183], v[116:119], v[36:39]
    v_mfma_f32_16x16x32_bf16 v[56:59], v[180:183], v[120:123], v[56:59]
    v_mfma_f32_16x16x32_bf16 v[76:79], v[180:183], v[124:127], v[76:79]
    s_waitcnt vmcnt(3)
    v_mfma_f32_16x16x32_bf16 v[20:23], v[184:187], v[112:115], v[20:23]
    v_mfma_f32_16x16x32_bf16 v[40:43], v[184:187], v[116:119], v[40:43]
    v_mfma_f32_16x16x32_bf16 v[60:63], v[184:187], v[120:123], v[60:63]
    v_mfma_f32_16x16x32_bf16 v[80:83], v[184:187], v[124:127], v[80:83]
    s_waitcnt vmcnt(2)
    v_mfma_f32_16x16x32_bf16 v[24:27], v[188:191], v[112:115], v[24:27]
    v_mfma_f32_16x16x32_bf16 v[44:47], v[188:191], v[116:119], v[44:47]
    v_mfma_f32_16x16x32_bf16 v[64:67], v[188:191], v[120:123], v[64:67]
    v_mfma_f32_16x16x32_bf16 v[84:87], v[188:191], v[124:127], v[84:87]
    s_waitcnt vmcnt(1)
    v_mfma_f32_16x16x32_bf16 v[28:31], v[192:195], v[112:115], v[28:31]
    v_mfma_f32_16x16x32_bf16 v[48:51], v[192:195], v[116:119], v[48:51]
    v_mfma_f32_16x16x32_bf16 v[68:71], v[192:195], v[120:123], v[68:71]
    v_mfma_f32_16x16x32_bf16 v[88:91], v[192:195], v[124:127], v[88:91]
    s_waitcnt vmcnt(0)
    v_mfma_f32_16x16x32_bf16 v[32:35], v[196:199], v[112:115], v[32:35]
    v_mfma_f32_16x16x32_bf16 v[52:55], v[196:199], v[116:119], v[52:55]
    v_mfma_f32_16x16x32_bf16 v[72:75], v[196:199], v[120:123], v[72:75]
    v_mfma_f32_16x16x32_bf16 v[92:95], v[196:199], v[124:127], v[92:95]
g2skip_61:
    s_waitcnt vmcnt(0)
    s_mul_i32 s63, s60, 15360
    v_add_u32 v3, s63, v2
    s_xor_b32 s64, s60, 1
    s_mul_i32 s64, s64, 15360
    v_add_u32 v4, s64, v2
    s_xor_b32 s64, s60, 2
    s_mul_i32 s64, s64, 15360
    v_add_u32 v5, s64, v2
    s_xor_b32 s64, s60, 3
    s_mul_i32 s64, s64, 15360
    v_add_u32 v12, s64, v2

    ds_write_b128 v3, v[36:39] offset:0
    ds_write_b128 v3, v[40:43] offset:1024
    ds_write_b128 v3, v[44:47] offset:2048
    ds_write_b128 v3, v[48:51] offset:3072
    ds_write_b128 v3, v[52:55] offset:4096
    ds_write_b128 v3, v[56:59] offset:5120
    ds_write_b128 v3, v[60:63] offset:6144
    ds_write_b128 v3, v[64:67] offset:7168
    ds_write_b128 v3, v[68:71] offset:8192
    ds_write_b128 v3, v[72:75] offset:9216
    ds_write_b128 v3, v[76:79] offset:10240
    ds_write_b128 v3, v[80:83] offset:11264
    ds_write_b128 v3, v[84:87] offset:12288
    ds_write_b128 v3, v[88:91] offset:13312
    ds_write_b128 v3, v[92:95] offset:14336
    v_lshrrev_b32 v6, 1, v2
    s_mul_i32 s64, s60, 2560
    s_add_u32 s64, s64, 86016
    v_add_u32 v6, s64, v6
    v_and_b32 v7, 15, v1
    s_lshl_b32 s63, s60, 4
    v_add_u32 v3, s63, v7
    v_mul_u32_u24 v7, 160, v3
    v_lshrrev_b32 v8, 4, v1
    v_lshl_add_u32 v7, v8, 3, v7
    v_add_u32 v7, 65536, v7
    s_lshl_b32 s63, s61, 6
    v_add_u32 v3, s63, v3
    v_mul_u32_u24 v9, 1280, v3
    v_lshl_add_u32 v10, v8, 3, v9
    v_and_b32 v11, 1, v8
    v_lshrrev_b32 v8, 1, v8
    v_lshl_add_u32 v8, v11, 1, v8
    v_lshl_add_u32 v9, v8, 4, v9
    s_mul_i32 s65, s62, 160
    s_mov_b32 s97, 0

    s_add_u32 s97, s97, 4
    v_mov_b32 v176, 161568
    v_mov_b32 v177, 1
    s_waitcnt lgkmcnt(0)
    s_mov_b64 exec, 1
    ds_add_u32 v176, v177
    s_mov_b64 exec, -1

gb_62:
    ds_read_b32 v177, v176
    s_waitcnt lgkmcnt(0)
    v_readfirstlane_b32 s63, v177
    s_add_u32 s96, s96, 1
    s_cmp_ge_u32 s96, 0x400000
    s_cselect_b32 s63, s97, s63
    s_cmp_lt_u32 s63, s97
    s_cbranch_scc1 gb_62

    ds_read_b128 v[96:99], v4 offset:0
    ds_read_b128 v[100:103], v5 offset:5120
    ds_read_b128 v[104:107], v12 offset:10240
    ds_read_b64 v[156:157], v7 offset:0
    ds_read_b128 v[108:111], v4 offset:1024
    ds_read_b128 v[112:115], v5 offset:6144
    ds_read_b128 v[116:119], v12 offset:11264
    ds_read_b64 v[158:159], v7 offset:32
    ds_read_b128 v[120:123], v4 offset:2048
    ds_read_b128 v[124:127], v5 offset:7168
    ds_read_b128 v[128:131], v12 offset:12288
    ds_read_b64 v[160:161], v7 offset:64
    v_sub_f32 v76, 0, v14
    v_sub_f32 v77, 0, v14
    v_mov_b32 v78, v15
    v_mov_b32 v79, v15
    v_mov_b32 v80, 0xbfb8aa3b
    v_mov_b32 v81, 0xbfb8aa3b
    v_mov_b32 v82, 1.0
    v_mov_b32 v83, 1.0

    s_waitcnt lgkmcnt(8)
    v_pk_add_f32 v[16:17], v[16:17], v[96:97]
    v_pk_add_f32 v[100:101], v[100:101], v[104:105]
    v_pk_add_f32 v[18:19], v[18:19], v[98:99]
    v_pk_add_f32 v[102:103], v[102:103], v[106:107]
    v_pk_add_f32 v[16:17], v[16:17], v[100:101]
    v_pk_add_f32 v[18:19], v[18:19], v[102:103]
    ds_read_b128 v[132:135], v4 offset:3072
    ds_read_b128 v[136:139], v5 offset:8192
    ds_read_b128 v[140:143], v12 offset:13312
    ds_read_b64 v[162:163], v7 offset:96
    v_pk_mul_f32 v[56:57], v[16:17], v[80:81]
    v_pk_mul_f32 v[58:59], v[18:19], v[80:81]
    v_exp_f32 v56, v56
    v_exp_f32 v57, v57
    v_exp_f32 v58, v58
    v_exp_f32 v59, v59
    v_lshlrev_b32 v36, 16, v156
    v_and_b32 v37, 0xffff0000, v156
    v_lshlrev_b32 v38, 16, v157
    v_and_b32 v39, 0xffff0000, v157
    v_pk_add_f32 v[56:57], v[56:57], v[82:83]
    v_pk_add_f32 v[58:59], v[58:59], v[82:83]
    v_rcp_f32 v56, v56
    v_rcp_f32 v57, v57
    v_rcp_f32 v58, v58
    v_rcp_f32 v59, v59
    v_pk_add_f32 v[96:97], v[36:37], v[76:77]
    v_pk_add_f32 v[98:99], v[38:39], v[76:77]
    v_pk_mul_f32 v[16:17], v[16:17], v[78:79]
    v_pk_mul_f32 v[18:19], v[18:19], v[78:79]
    v_pk_mul_f32 v[16:17], v[16:17], v[56:57]
    v_pk_mul_f32 v[18:19], v[18:19], v[58:59]
    v_pk_mul_f32 v[16:17], v[16:17], v[96:97]
    v_pk_mul_f32 v[18:19], v[18:19], v[98:99]
    s_waitcnt lgkmcnt(8)
    v_pk_add_f32 v[20:21], v[20:21], v[108:109]
    v_pk_add_f32 v[112:113], v[112:113], v[116:117]
    v_pk_add_f32 v[22:23], v[22:23], v[110:111]
    v_pk_add_f32 v[114:115], v[114:115], v[118:119]
    v_pk_add_f32 v[20:21], v[20:21], v[112:113]
    v_pk_add_f32 v[22:23], v[22:23], v[114:115]
    ds_read_b128 v[144:147], v4 offset:4096
    ds_read_b128 v[148:151], v5 offset:9216
    ds_read_b128 v[152:155], v12 offset:14336
    ds_read_b64 v[164:165], v7 offset:128
    v_pk_mul_f32 v[56:57], v[20:21], v[80:81]
    v_pk_mul_f32 v[58:59], v[22:23], v[80:81]
    v_exp_f32 v56, v56
    v_exp_f32 v57, v57
    v_exp_f32 v58, v58
    v_exp_f32 v59, v59
    v_lshlrev_b32 v40, 16, v158
    v_and_b32 v41, 0xffff0000, v158
    v_lshlrev_b32 v42, 16, v159
    v_and_b32 v43, 0xffff0000, v159
    v_pk_add_f32 v[56:57], v[56:57], v[82:83]
    v_pk_add_f32 v[58:59], v[58:59], v[82:83]
    v_rcp_f32 v56, v56
    v_rcp_f32 v57, v57
    v_rcp_f32 v58, v58
    v_rcp_f32 v59, v59
    v_pk_add_f32 v[108:109], v[40:41], v[76:77]
    v_pk_add_f32 v[110:111], v[42:43], v[76:77]
    v_pk_mul_f32 v[20:21], v[20:21], v[78:79]
    v_pk_mul_f32 v[22:23], v[22:23], v[78:79]
    v_pk_mul_f32 v[20:21], v[20:21], v[56:57]
    v_pk_mul_f32 v[22:23], v[22:23], v[58:59]
    v_pk_mul_f32 v[20:21], v[20:21], v[108:109]
    v_pk_mul_f32 v[22:23], v[22:23], v[110:111]
    s_waitcnt lgkmcnt(8)
    v_pk_add_f32 v[24:25], v[24:25], v[120:121]
    v_pk_add_f32 v[124:125], v[124:125], v[128:129]
    v_pk_add_f32 v[26:27], v[26:27], v[122:123]
    v_pk_add_f32 v[126:127], v[126:127], v[130:131]
    v_pk_add_f32 v[24:25], v[24:25], v[124:125]
    v_pk_add_f32 v[26:27], v[26:27], v[126:127]
    v_pk_mul_f32 v[56:57], v[24:25], v[80:81]
    v_pk_mul_f32 v[58:59], v[26:27], v[80:81]
    v_exp_f32 v56, v56
    v_exp_f32 v57, v57
    v_exp_f32 v58, v58
    v_exp_f32 v59, v59
    v_lshlrev_b32 v44, 16, v160
    v_and_b32 v45, 0xffff0000, v160
    v_lshlrev_b32 v46, 16, v161
    v_and_b32 v47, 0xffff0000, v161
    v_pk_add_f32 v[56:57], v[56:57], v[82:83]
    v_pk_add_f32 v[58:59], v[58:59], v[82:83]
    v_rcp_f32 v56, v56
    v_rcp_f32 v57, v57
    v_rcp_f32 v58, v58
    v_rcp_f32 v59, v59
    v_pk_add_f32 v[120:121], v[44:45], v[76:77]
    v_pk_add_f32 v[122:123], v[46:47], v[76:77]
    v_pk_mul_f32 v[24:25], v[24:25], v[78:79]
    v_pk_mul_f32 v[26:27], v[26:27], v[78:79]
    v_pk_mul_f32 v[24:25], v[24:25], v[56:57]
    v_pk_mul_f32 v[26:27], v[26:27], v[58:59]
    v_pk_mul_f32 v[24:25], v[24:25], v[120:121]
    v_pk_mul_f32 v[26:27], v[26:27], v[122:123]
    s_waitcnt lgkmcnt(4)
    v_pk_add_f32 v[28:29], v[28:29], v[132:133]
    v_pk_add_f32 v[136:137], v[136:137], v[140:141]
    v_pk_add_f32 v[30:31], v[30:31], v[134:135]
    v_pk_add_f32 v[138:139], v[138:139], v[142:143]
    v_pk_add_f32 v[28:29], v[28:29], v[136:137]
    v_pk_add_f32 v[30:31], v[30:31], v[138:139]
    v_pk_mul_f32 v[56:57], v[28:29], v[80:81]
    v_pk_mul_f32 v[58:59], v[30:31], v[80:81]
    v_exp_f32 v56, v56
    v_exp_f32 v57, v57
    v_exp_f32 v58, v58
    v_exp_f32 v59, v59
    v_lshlrev_b32 v48, 16, v162
    v_and_b32 v49, 0xffff0000, v162
    v_lshlrev_b32 v50, 16, v163
    v_and_b32 v51, 0xffff0000, v163
    v_pk_add_f32 v[56:57], v[56:57], v[82:83]
    v_pk_add_f32 v[58:59], v[58:59], v[82:83]
    v_rcp_f32 v56, v56
    v_rcp_f32 v57, v57
    v_rcp_f32 v58, v58
    v_rcp_f32 v59, v59
    v_pk_add_f32 v[132:133], v[48:49], v[76:77]
    v_pk_add_f32 v[134:135], v[50:51], v[76:77]
    v_pk_mul_f32 v[28:29], v[28:29], v[78:79]
    v_pk_mul_f32 v[30:31], v[30:31], v[78:79]
    v_pk_mul_f32 v[28:29], v[28:29], v[56:57]
    v_pk_mul_f32 v[30:31], v[30:31], v[58:59]
    v_pk_mul_f32 v[28:29], v[28:29], v[132:133]
    v_pk_mul_f32 v[30:31], v[30:31], v[134:135]
    s_waitcnt lgkmcnt(0)
    v_pk_add_f32 v[32:33], v[32:33], v[144:145]
    v_pk_add_f32 v[148:149], v[148:149], v[152:153]
    v_pk_add_f32 v[34:35], v[34:35], v[146:147]
    v_pk_add_f32 v[150:151], v[150:151], v[154:155]
    v_pk_add_f32 v[32:33], v[32:33], v[148:149]
    v_pk_add_f32 v[34:35], v[34:35], v[150:151]
    v_pk_mul_f32 v[56:57], v[32:33], v[80:81]
    v_pk_mul_f32 v[58:59], v[34:35], v[80:81]
    v_exp_f32 v56, v56
    v_exp_f32 v57, v57
    v_exp_f32 v58, v58
    v_exp_f32 v59, v59
    v_lshlrev_b32 v52, 16, v164
    v_and_b32 v53, 0xffff0000, v164
    v_lshlrev_b32 v54, 16, v165
    v_and_b32 v55, 0xffff0000, v165
    v_pk_add_f32 v[56:57], v[56:57], v[82:83]
    v_pk_add_f32 v[58:59], v[58:59], v[82:83]
    v_rcp_f32 v56, v56
    v_rcp_f32 v57, v57
    v_rcp_f32 v58, v58
    v_rcp_f32 v59, v59
    v_pk_add_f32 v[144:145], v[52:53], v[76:77]
    v_pk_add_f32 v[146:147], v[54:55], v[76:77]
    v_pk_mul_f32 v[32:33], v[32:33], v[78:79]
    v_pk_mul_f32 v[34:35], v[34:35], v[78:79]
    v_pk_mul_f32 v[32:33], v[32:33], v[56:57]
    v_pk_mul_f32 v[34:35], v[34:35], v[58:59]
    v_pk_mul_f32 v[32:33], v[32:33], v[144:145]
    v_pk_mul_f32 v[34:35], v[34:35], v[146:147]
    s_barrier
    ds_read_b64_tr_b16 v[166:167], v6 offset:0
    ds_read_b64_tr_b16 v[168:169], v6 offset:512
    ds_read_b64_tr_b16 v[170:171], v6 offset:1024
    ds_read_b64_tr_b16 v[172:173], v6 offset:1536
    ds_read_b64_tr_b16 v[174:175], v6 offset:2048
    s_waitcnt lgkmcnt(4)
    v_lshlrev_b32 v56, 16, v166
    v_and_b32 v57, 0xffff0000, v166
    v_lshlrev_b32 v58, 16, v167
    v_and_b32 v59, 0xffff0000, v167
    v_pk_fma_f32 v[36:37], v[16:17], v[56:57], v[36:37]
    v_pk_fma_f32 v[38:39], v[18:19], v[58:59], v[38:39]
    v_cvt_pk_bf16_f32 v176, v36, v37
    v_cvt_pk_bf16_f32 v177, v38, v39
    s_waitcnt lgkmcnt(3)
    v_lshlrev_b32 v60, 16, v168
    v_and_b32 v61, 0xffff0000, v168
    v_lshlrev_b32 v62, 16, v169
    v_and_b32 v63, 0xffff0000, v169
    v_pk_fma_f32 v[40:41], v[20:21], v[60:61], v[40:41]
    v_pk_fma_f32 v[42:43], v[22:23], v[62:63], v[42:43]
    v_cvt_pk_bf16_f32 v178, v40, v41
    v_cvt_pk_bf16_f32 v179, v42, v43
    s_nop 1
    v_permlane16_swap_b32 v176, v178
    v_permlane16_swap_b32 v177, v179
    s_nop 1
    buffer_store_dwordx4 v[176:179], v9, s[32:35], s65 offen offset:0
    s_waitcnt lgkmcnt(2)
    v_lshlrev_b32 v56, 16, v170
    v_and_b32 v57, 0xffff0000, v170
    v_lshlrev_b32 v58, 16, v171
    v_and_b32 v59, 0xffff0000, v171
    v_pk_fma_f32 v[44:45], v[24:25], v[56:57], v[44:45]
    v_pk_fma_f32 v[46:47], v[26:27], v[58:59], v[46:47]
    v_cvt_pk_bf16_f32 v180, v44, v45
    v_cvt_pk_bf16_f32 v181, v46, v47
    s_waitcnt lgkmcnt(1)
    v_lshlrev_b32 v60, 16, v172
    v_and_b32 v61, 0xffff0000, v172
    v_lshlrev_b32 v62, 16, v173
    v_and_b32 v63, 0xffff0000, v173
    v_pk_fma_f32 v[48:49], v[28:29], v[60:61], v[48:49]
    v_pk_fma_f32 v[50:51], v[30:31], v[62:63], v[50:51]
    v_cvt_pk_bf16_f32 v182, v48, v49
    v_cvt_pk_bf16_f32 v183, v50, v51
    s_nop 1
    v_permlane16_swap_b32 v180, v182
    v_permlane16_swap_b32 v181, v183
    s_nop 1
    buffer_store_dwordx4 v[180:183], v9, s[32:35], s65 offen offset:64
    s_waitcnt lgkmcnt(0)
    v_lshlrev_b32 v56, 16, v174
    v_and_b32 v57, 0xffff0000, v174
    v_lshlrev_b32 v58, 16, v175
    v_and_b32 v59, 0xffff0000, v175
    v_pk_fma_f32 v[52:53], v[32:33], v[56:57], v[52:53]
    v_pk_fma_f32 v[54:55], v[34:35], v[58:59], v[54:55]
    v_cvt_pk_bf16_f32 v184, v52, v53
    v_cvt_pk_bf16_f32 v185, v54, v55
    buffer_store_dwordx2 v[184:185], v10, s[32:35], s65 offen offset:128
    s_endpgm
k1_prep:
    s_waitcnt lgkmcnt(0)
    s_mov_b32 s32, s6
    s_and_b32 s33, s7, 0xffff
    s_mov_b32 s34, 2621440
    s_mov_b32 s35, 0x00020000
    s_mov_b32 s36, s8
    s_and_b32 s37, s9, 0xffff
    s_mov_b32 s38, 2621440
    s_mov_b32 s39, 0x00020000
    s_mov_b32 s40, s10
    s_and_b32 s41, s11, 0xffff
    s_mov_b32 s42, 5120
    s_mov_b32 s43, 0x00020000
    s_mov_b32 s48, s20
    s_and_b32 s49, s21, 0xffff
    s_mov_b32 s50, 2211840
    s_mov_b32 s51, 0x00020000
    s_mov_b32 s52, s26
    s_and_b32 s53, s27, 0xffff
    s_mov_b32 s54, 17825792
    s_mov_b32 s55, 0x00020000
    v_and_b32 v1, 63, v0
    v_lshrrev_b32 v2, 6, v0
    s_cmp_ge_u32 s2, 54
    v_readfirstlane_b32 s60, v2
    s_cselect_b32 s62, 54, 0
    s_sub_u32 s61, s2, s62

    s_mov_b32 s56, s24
    s_and_b32 s57, s25, 0xffff
    s_mov_b32 s58, 256
    s_mov_b32 s59, 0x00020000
    s_mov_b32 s89, 0
    s_cmp_eq_u32 s60, 2
    s_cbranch_scc1 prepC_64
    s_cmp_lt_u32 s60, 2
    s_cbranch_scc1 prepB_63
    s_setprio 2
    s_mul_i32 s62, s2, 5
    s_add_u32 s62, s62, s60
    s_sub_u32 s62, s62, 3
    s_mul_i32 s63, s62, 6554
    s_lshr_b32 s63, s63, 16
    s_mul_i32 s64, s63, 10
    s_sub_u32 s64, s62, s64
    v_lshrrev_b32 v2, 3, v1
    v_and_b32 v3, 7, v1
    s_lshl_b32 s65, s63, 3
    v_add_u32 v2, s65, v2
    s_lshl_b32 s65, s64, 3
    v_add_u32 v3, s65, v3
    v_lshlrev_b32 v4, 6, v3
    v_mul_u32_u24 v5, 10240, v2
    v_lshl_add_u32 v5, v3, 4, v5
    v_lshlrev_b32 v9, 15, v3
    v_lshlrev_b32 v6, 4, v2
    v_sub_u32 v9, v9, v6
    v_add_u32 v9, 4080, v9

    buffer_load_dwordx4 v[56:59], v4, s[40:43], 0 offen offset:0
    buffer_load_dwordx4 v[60:63], v4, s[40:43], 0 offen offset:16
    buffer_load_dwordx4 v[64:67], v4, s[40:43], 0 offen offset:32
    buffer_load_dwordx4 v[68:71], v4, s[40:43], 0 offen offset:48
    v_add_u32 v6, 4294963456, v5
    buffer_load_dwordx4 v[72:75], v6, s[32:35], 0 offen
    v_add_u32 v6, 4294964736, v5
    buffer_load_dwordx4 v[76:79], v6, s[32:35], 0 offen
    v_add_u32 v6, 4294966016, v5
    buffer_load_dwordx4 v[80:83], v6, s[32:35], 0 offen
    v_add_u32 v6, 0, v5
    buffer_load_dwordx4 v[84:87], v6, s[32:35], 0 offen
    v_add_u32 v6, 1280, v5
    buffer_load_dwordx4 v[88:91], v6, s[32:35], 0 offen
    v_add_u32 v6, 2560, v5
    buffer_load_dwordx4 v[92:95], v6, s[32:35], 0 offen
    v_add_u32 v6, 3840, v5
    buffer_load_dwordx4 v[96:99], v6, s[32:35], 0 offen
    v_add_u32 v6, 5120, v5
    buffer_load_dwordx4 v[100:103], v6, s[32:35], 0 offen
    v_add_u32 v6, 6400, v5
    buffer_load_dwordx4 v[104:107], v6, s[32:35], 0 offen
    v_add_u32 v6, 7680, v5
    buffer_load_dwordx4 v[108:111], v6, s[32:35], 0 offen
    v_add_u32 v6, 8960, v5
    buffer_load_dwordx4 v[112:115], v6, s[32:35], 0 offen
    v_add_u32 v6, 0, v5
    buffer_load_dwordx4 v[116:119], v6, s[36:39], 0 offen
    v_add_u32 v6, 1280, v5
    buffer_load_dwordx4 v[120:123], v6, s[36:39], 0 offen
    v_add_u32 v6, 2560, v5
    buffer_load_dwordx4 v[124:127], v6, s[36:39], 0 offen
    v_add_u32 v6, 3840, v5
    buffer_load_dwordx4 v[128:131], v6, s[36:39], 0 offen
    v_add_u32 v6, 5120, v5
    buffer_load_dwordx4 v[132:135], v6, s[36:39], 0 offen
    v_add_u32 v6, 6400, v5
    buffer_load_dwordx4 v[136:139], v6, s[36:39], 0 offen
    v_add_u32 v6, 7680, v5
    buffer_load_dwordx4 v[140:143], v6, s[36:39], 0 offen
    v_add_u32 v6, 8960, v5
    buffer_load_dwordx4 v[144:147], v6, s[36:39], 0 offen
    s_barrier
    s_waitcnt vmcnt(8)
    v_lshlrev_b32 v16, 16, v56
    v_and_b32 v24, 0xffff0000, v56
    v_lshlrev_b32 v32, 16, v57
    v_and_b32 v40, 0xffff0000, v57
    v_lshlrev_b32 v17, 16, v58
    v_and_b32 v25, 0xffff0000, v58
    v_lshlrev_b32 v33, 16, v59
    v_and_b32 v41, 0xffff0000, v59
    v_lshlrev_b32 v18, 16, v60
    v_and_b32 v26, 0xffff0000, v60
    v_lshlrev_b32 v34, 16, v61
    v_and_b32 v42, 0xffff0000, v61
    v_lshlrev_b32 v19, 16, v62
    v_and_b32 v27, 0xffff0000, v62
    v_lshlrev_b32 v35, 16, v63
    v_and_b32 v43, 0xffff0000, v63
    v_lshlrev_b32 v20, 16, v64
    v_and_b32 v28, 0xffff0000, v64
    v_lshlrev_b32 v36, 16, v65
    v_and_b32 v44, 0xffff0000, v65
    v_lshlrev_b32 v21, 16, v66
    v_and_b32 v29, 0xffff0000, v66
    v_lshlrev_b32 v37, 16, v67
    v_and_b32 v45, 0xffff0000, v67
    v_lshlrev_b32 v22, 16, v68
    v_and_b32 v30, 0xffff0000, v68
    v_lshlrev_b32 v38, 16, v69
    v_and_b32 v46, 0xffff0000, v69
    v_lshlrev_b32 v23, 16, v70
    v_and_b32 v31, 0xffff0000, v70
    v_lshlrev_b32 v39, 16, v71
    v_and_b32 v47, 0xffff0000, v71
    v_lshlrev_b32 v148, 16, v72
    v_and_b32 v149, 0xffff0000, v72
    v_lshlrev_b32 v150, 16, v73
    v_and_b32 v151, 0xffff0000, v73
    v_lshlrev_b32 v152, 16, v74
    v_and_b32 v153, 0xffff0000, v74
    v_lshlrev_b32 v154, 16, v75
    v_and_b32 v155, 0xffff0000, v75
    v_lshlrev_b32 v156, 16, v76
    v_and_b32 v157, 0xffff0000, v76
    v_lshlrev_b32 v158, 16, v77
    v_and_b32 v159, 0xffff0000, v77
    v_lshlrev_b32 v160, 16, v78
    v_and_b32 v161, 0xffff0000, v78
    v_lshlrev_b32 v162, 16, v79
    v_and_b32 v163, 0xffff0000, v79
    v_lshlrev_b32 v164, 16, v80
    v_and_b32 v165, 0xffff0000, v80
    v_lshlrev_b32 v166, 16, v81
    v_and_b32 v167, 0xffff0000, v81
    v_lshlrev_b32 v168, 16, v82
    v_and_b32 v169, 0xffff0000, v82
    v_lshlrev_b32 v170, 16, v83
    v_and_b32 v171, 0xffff0000, v83
    v_lshlrev_b32 v172, 16, v84
    v_and_b32 v173, 0xffff0000, v84
    v_lshlrev_b32 v174, 16, v85
    v_and_b32 v175, 0xffff0000, v85
    v_lshlrev_b32 v176, 16, v86
    v_and_b32 v177, 0xffff0000, v86
    v_lshlrev_b32 v178, 16, v87
    v_and_b32 v179, 0xffff0000, v87
    v_lshlrev_b32 v180, 16, v88
    v_and_b32 v181, 0xffff0000, v88
    v_lshlrev_b32 v182, 16, v89
    v_and_b32 v183, 0xffff0000, v89
    v_lshlrev_b32 v184, 16, v90
    v_and_b32 v185, 0xffff0000, v90
    v_lshlrev_b32 v186, 16, v91
    v_and_b32 v187, 0xffff0000, v91
    v_lshlrev_b32 v188, 16, v92
    v_and_b32 v189, 0xffff0000, v92
    v_lshlrev_b32 v190, 16, v93
    v_and_b32 v191, 0xffff0000, v93
    v_lshlrev_b32 v192, 16, v94
    v_and_b32 v193, 0xffff0000, v94
    v_lshlrev_b32 v194, 16, v95
    v_and_b32 v195, 0xffff0000, v95
    v_lshlrev_b32 v196, 16, v96
    v_and_b32 v197, 0xffff0000, v96
    v_lshlrev_b32 v198, 16, v97
    v_and_b32 v199, 0xffff0000, v97
    v_lshlrev_b32 v200, 16, v98
    v_and_b32 v201, 0xffff0000, v98
    v_lshlrev_b32 v202, 16, v99
    v_and_b32 v203, 0xffff0000, v99
    v_lshlrev_b32 v204, 16, v100
    v_and_b32 v205, 0xffff0000, v100
    v_lshlrev_b32 v206, 16, v101
    v_and_b32 v207, 0xffff0000, v101
    v_lshlrev_b32 v208, 16, v102
    v_and_b32 v209, 0xffff0000, v102
    v_lshlrev_b32 v210, 16, v103
    v_and_b32 v211, 0xffff0000, v103
    v_lshlrev_b32 v212, 16, v104
    v_and_b32 v213, 0xffff0000, v104
    v_lshlrev_b32 v214, 16, v105
    v_and_b32 v215, 0xffff0000, v105
    v_lshlrev_b32 v216, 16, v106
    v_and_b32 v217, 0xffff0000, v106
    v_lshlrev_b32 v218, 16, v107
    v_and_b32 v219, 0xffff0000, v107
    v_lshlrev_b32 v220, 16, v108
    v_and_b32 v221, 0xffff0000, v108
    v_lshlrev_b32 v222, 16, v109
    v_and_b32 v223, 0xffff0000, v109
    v_lshlrev_b32 v224, 16, v110
    v_and_b32 v225, 0xffff0000, v110
    v_lshlrev_b32 v226, 16, v111
    v_and_b32 v227, 0xffff0000, v111
    v_lshlrev_b32 v228, 16, v112
    v_and_b32 v229, 0xffff0000, v112
    v_lshlrev_b32 v230, 16, v113
    v_and_b32 v231, 0xffff0000, v113
    v_lshlrev_b32 v232, 16, v114
    v_and_b32 v233, 0xffff0000, v114
    v_lshlrev_b32 v234, 16, v115
    v_and_b32 v235, 0xffff0000, v115
    s_waitcnt vmcnt(0)
    v_pk_mul_f32 v[236:237], v[204:205], v[40:41]
    v_pk_fma_f32 v[236:237], v[212:213], v[32:33], v[236:237]
    v_pk_fma_f32 v[236:237], v[220:221], v[24:25], v[236:237]
    v_pk_fma_f32 v[236:237], v[228:229], v[16:17], v[236:237]
    v_lshlrev_b32 v2, 16, v144
    v_and_b32 v3, 0xffff0000, v144
    v_pk_mul_f32 v[236:237], v[236:237], v[2:3]
    v_pk_mul_f32 v[238:239], v[206:207], v[42:43]
    v_pk_fma_f32 v[238:239], v[214:215], v[34:35], v[238:239]
    v_pk_fma_f32 v[238:239], v[222:223], v[26:27], v[238:239]
    v_pk_fma_f32 v[238:239], v[230:231], v[18:19], v[238:239]
    v_lshlrev_b32 v2, 16, v145
    v_and_b32 v3, 0xffff0000, v145
    v_pk_mul_f32 v[238:239], v[238:239], v[2:3]
    v_pk_mul_f32 v[240:241], v[208:209], v[44:45]
    v_pk_fma_f32 v[240:241], v[216:217], v[36:37], v[240:241]
    v_pk_fma_f32 v[240:241], v[224:225], v[28:29], v[240:241]
    v_pk_fma_f32 v[240:241], v[232:233], v[20:21], v[240:241]
    v_lshlrev_b32 v2, 16, v146
    v_and_b32 v3, 0xffff0000, v146
    v_pk_mul_f32 v[240:241], v[240:241], v[2:3]
    v_pk_mul_f32 v[242:243], v[210:211], v[46:47]
    v_pk_fma_f32 v[242:243], v[218:219], v[38:39], v[242:243]
    v_pk_fma_f32 v[242:243], v[226:227], v[30:31], v[242:243]
    v_pk_fma_f32 v[242:243], v[234:235], v[22:23], v[242:243]
    v_lshlrev_b32 v2, 16, v147
    v_and_b32 v3, 0xffff0000, v147
    v_pk_mul_f32 v[242:243], v[242:243], v[2:3]
    v_pk_mul_f32 v[244:245], v[196:197], v[40:41]
    v_pk_fma_f32 v[244:245], v[204:205], v[32:33], v[244:245]
    v_pk_fma_f32 v[244:245], v[212:213], v[24:25], v[244:245]
    v_pk_fma_f32 v[244:245], v[220:221], v[16:17], v[244:245]
    v_lshlrev_b32 v2, 16, v140
    v_and_b32 v3, 0xffff0000, v140
    v_pk_mul_f32 v[244:245], v[244:245], v[2:3]
    v_pk_mul_f32 v[246:247], v[198:199], v[42:43]
    v_pk_fma_f32 v[246:247], v[206:207], v[34:35], v[246:247]
    v_pk_fma_f32 v[246:247], v[214:215], v[26:27], v[246:247]
    v_pk_fma_f32 v[246:247], v[222:223], v[18:19], v[246:247]
    v_lshlrev_b32 v2, 16, v141
    v_and_b32 v3, 0xffff0000, v141
    v_pk_mul_f32 v[246:247], v[246:247], v[2:3]
    v_pk_mul_f32 v[248:249], v[200:201], v[44:45]
    v_pk_fma_f32 v[248:249], v[208:209], v[36:37], v[248:249]
    v_pk_fma_f32 v[248:249], v[216:217], v[28:29], v[248:249]
    v_pk_fma_f32 v[248:249], v[224:225], v[20:21], v[248:249]
    v_lshlrev_b32 v2, 16, v142
    v_and_b32 v3, 0xffff0000, v142
    v_pk_mul_f32 v[248:249], v[248:249], v[2:3]
    v_pk_mul_f32 v[250:251], v[202:203], v[46:47]
    v_pk_fma_f32 v[250:251], v[210:211], v[38:39], v[250:251]
    v_pk_fma_f32 v[250:251], v[218:219], v[30:31], v[250:251]
    v_pk_fma_f32 v[250:251], v[226:227], v[22:23], v[250:251]
    v_lshlrev_b32 v2, 16, v143
    v_and_b32 v3, 0xffff0000, v143
    v_pk_mul_f32 v[250:251], v[250:251], v[2:3]
    v_cvt_pk_bf16_f32 v72, v236, v244
    v_cvt_pk_bf16_f32 v76, v237, v245
    v_cvt_pk_bf16_f32 v80, v238, v246
    v_cvt_pk_bf16_f32 v84, v239, v247
    v_cvt_pk_bf16_f32 v88, v240, v248
    v_cvt_pk_bf16_f32 v92, v241, v249
    v_cvt_pk_bf16_f32 v96, v242, v250
    v_cvt_pk_bf16_f32 v100, v243, v251
    v_pk_mul_f32 v[236:237], v[188:189], v[40:41]
    v_pk_fma_f32 v[236:237], v[196:197], v[32:33], v[236:237]
    v_pk_fma_f32 v[236:237], v[204:205], v[24:25], v[236:237]
    v_pk_fma_f32 v[236:237], v[212:213], v[16:17], v[236:237]
    v_lshlrev_b32 v2, 16, v136
    v_and_b32 v3, 0xffff0000, v136
    v_pk_mul_f32 v[236:237], v[236:237], v[2:3]
    v_pk_mul_f32 v[238:239], v[190:191], v[42:43]
    v_pk_fma_f32 v[238:239], v[198:199], v[34:35], v[238:239]
    v_pk_fma_f32 v[238:239], v[206:207], v[26:27], v[238:239]
    v_pk_fma_f32 v[238:239], v[214:215], v[18:19], v[238:239]
    v_lshlrev_b32 v2, 16, v137
    v_and_b32 v3, 0xffff0000, v137
    v_pk_mul_f32 v[238:239], v[238:239], v[2:3]
    v_pk_mul_f32 v[240:241], v[192:193], v[44:45]
    v_pk_fma_f32 v[240:241], v[200:201], v[36:37], v[240:241]
    v_pk_fma_f32 v[240:241], v[208:209], v[28:29], v[240:241]
    v_pk_fma_f32 v[240:241], v[216:217], v[20:21], v[240:241]
    v_lshlrev_b32 v2, 16, v138
    v_and_b32 v3, 0xffff0000, v138
    v_pk_mul_f32 v[240:241], v[240:241], v[2:3]
    v_pk_mul_f32 v[242:243], v[194:195], v[46:47]
    v_pk_fma_f32 v[242:243], v[202:203], v[38:39], v[242:243]
    v_pk_fma_f32 v[242:243], v[210:211], v[30:31], v[242:243]
    v_pk_fma_f32 v[242:243], v[218:219], v[22:23], v[242:243]
    v_lshlrev_b32 v2, 16, v139
    v_and_b32 v3, 0xffff0000, v139
    v_pk_mul_f32 v[242:243], v[242:243], v[2:3]
    v_pk_mul_f32 v[244:245], v[180:181], v[40:41]
    v_pk_fma_f32 v[244:245], v[188:189], v[32:33], v[244:245]
    v_pk_fma_f32 v[244:245], v[196:197], v[24:25], v[244:245]
    v_pk_fma_f32 v[244:245], v[204:205], v[16:17], v[244:245]
    v_lshlrev_b32 v2, 16, v132
    v_and_b32 v3, 0xffff0000, v132
    v_pk_mul_f32 v[244:245], v[244:245], v[2:3]
    v_pk_mul_f32 v[246:247], v[182:183], v[42:43]
    v_pk_fma_f32 v[246:247], v[190:191], v[34:35], v[246:247]
    v_pk_fma_f32 v[246:247], v[198:199], v[26:27], v[246:247]
    v_pk_fma_f32 v[246:247], v[206:207], v[18:19], v[246:247]
    v_lshlrev_b32 v2, 16, v133
    v_and_b32 v3, 0xffff0000, v133
    v_pk_mul_f32 v[246:247], v[246:247], v[2:3]
    v_pk_mul_f32 v[248:249], v[184:185], v[44:45]
    v_pk_fma_f32 v[248:249], v[192:193], v[36:37], v[248:249]
    v_pk_fma_f32 v[248:249], v[200:201], v[28:29], v[248:249]
    v_pk_fma_f32 v[248:249], v[208:209], v[20:21], v[248:249]
    v_lshlrev_b32 v2, 16, v134
    v_and_b32 v3, 0xffff0000, v134
    v_pk_mul_f32 v[248:249], v[248:249], v[2:3]
    v_pk_mul_f32 v[250:251], v[186:187], v[46:47]
    v_pk_fma_f32 v[250:251], v[194:195], v[38:39], v[250:251]
    v_pk_fma_f32 v[250:251], v[202:203], v[30:31], v[250:251]
    v_pk_fma_f32 v[250:251], v[210:211], v[22:23], v[250:251]
    v_lshlrev_b32 v2, 16, v135
    v_and_b32 v3, 0xffff0000, v135
    v_pk_mul_f32 v[250:251], v[250:251], v[2:3]
    v_cvt_pk_bf16_f32 v73, v236, v244
    v_cvt_pk_bf16_f32 v77, v237, v245
    v_cvt_pk_bf16_f32 v81, v238, v246
    v_cvt_pk_bf16_f32 v85, v239, v247
    v_cvt_pk_bf16_f32 v89, v240, v248
    v_cvt_pk_bf16_f32 v93, v241, v249
    v_cvt_pk_bf16_f32 v97, v242, v250
    v_cvt_pk_bf16_f32 v101, v243, v251
    v_pk_mul_f32 v[236:237], v[172:173], v[40:41]
    v_pk_fma_f32 v[236:237], v[180:181], v[32:33], v[236:237]
    v_pk_fma_f32 v[236:237], v[188:189], v[24:25], v[236:237]
    v_pk_fma_f32 v[236:237], v[196:197], v[16:17], v[236:237]
    v_lshlrev_b32 v2, 16, v128
    v_and_b32 v3, 0xffff0000, v128
    v_pk_mul_f32 v[236:237], v[236:237], v[2:3]
    v_pk_mul_f32 v[238:239], v[174:175], v[42:43]
    v_pk_fma_f32 v[238:239], v[182:183], v[34:35], v[238:239]
    v_pk_fma_f32 v[238:239], v[190:191], v[26:27], v[238:239]
    v_pk_fma_f32 v[238:239], v[198:199], v[18:19], v[238:239]
    v_lshlrev_b32 v2, 16, v129
    v_and_b32 v3, 0xffff0000, v129
    v_pk_mul_f32 v[238:239], v[238:239], v[2:3]
    v_pk_mul_f32 v[240:241], v[176:177], v[44:45]
    v_pk_fma_f32 v[240:241], v[184:185], v[36:37], v[240:241]
    v_pk_fma_f32 v[240:241], v[192:193], v[28:29], v[240:241]
    v_pk_fma_f32 v[240:241], v[200:201], v[20:21], v[240:241]
    v_lshlrev_b32 v2, 16, v130
    v_and_b32 v3, 0xffff0000, v130
    v_pk_mul_f32 v[240:241], v[240:241], v[2:3]
    v_pk_mul_f32 v[242:243], v[178:179], v[46:47]
    v_pk_fma_f32 v[242:243], v[186:187], v[38:39], v[242:243]
    v_pk_fma_f32 v[242:243], v[194:195], v[30:31], v[242:243]
    v_pk_fma_f32 v[242:243], v[202:203], v[22:23], v[242:243]
    v_lshlrev_b32 v2, 16, v131
    v_and_b32 v3, 0xffff0000, v131
    v_pk_mul_f32 v[242:243], v[242:243], v[2:3]
    v_pk_mul_f32 v[244:245], v[164:165], v[40:41]
    v_pk_fma_f32 v[244:245], v[172:173], v[32:33], v[244:245]
    v_pk_fma_f32 v[244:245], v[180:181], v[24:25], v[244:245]
    v_pk_fma_f32 v[244:245], v[188:189], v[16:17], v[244:245]
    v_lshlrev_b32 v2, 16, v124
    v_and_b32 v3, 0xffff0000, v124
    v_pk_mul_f32 v[244:245], v[244:245], v[2:3]
    v_pk_mul_f32 v[246:247], v[166:167], v[42:43]
    v_pk_fma_f32 v[246:247], v[174:175], v[34:35], v[246:247]
    v_pk_fma_f32 v[246:247], v[182:183], v[26:27], v[246:247]
    v_pk_fma_f32 v[246:247], v[190:191], v[18:19], v[246:247]
    v_lshlrev_b32 v2, 16, v125
    v_and_b32 v3, 0xffff0000, v125
    v_pk_mul_f32 v[246:247], v[246:247], v[2:3]
    v_pk_mul_f32 v[248:249], v[168:169], v[44:45]
    v_pk_fma_f32 v[248:249], v[176:177], v[36:37], v[248:249]
    v_pk_fma_f32 v[248:249], v[184:185], v[28:29], v[248:249]
    v_pk_fma_f32 v[248:249], v[192:193], v[20:21], v[248:249]
    v_lshlrev_b32 v2, 16, v126
    v_and_b32 v3, 0xffff0000, v126
    v_pk_mul_f32 v[248:249], v[248:249], v[2:3]
    v_pk_mul_f32 v[250:251], v[170:171], v[46:47]
    v_pk_fma_f32 v[250:251], v[178:179], v[38:39], v[250:251]
    v_pk_fma_f32 v[250:251], v[186:187], v[30:31], v[250:251]
    v_pk_fma_f32 v[250:251], v[194:195], v[22:23], v[250:251]
    v_lshlrev_b32 v2, 16, v127
    v_and_b32 v3, 0xffff0000, v127
    v_pk_mul_f32 v[250:251], v[250:251], v[2:3]
    v_cvt_pk_bf16_f32 v74, v236, v244
    v_cvt_pk_bf16_f32 v78, v237, v245
    v_cvt_pk_bf16_f32 v82, v238, v246
    v_cvt_pk_bf16_f32 v86, v239, v247
    v_cvt_pk_bf16_f32 v90, v240, v248
    v_cvt_pk_bf16_f32 v94, v241, v249
    v_cvt_pk_bf16_f32 v98, v242, v250
    v_cvt_pk_bf16_f32 v102, v243, v251
    v_pk_mul_f32 v[236:237], v[156:157], v[40:41]
    v_pk_fma_f32 v[236:237], v[164:165], v[32:33], v[236:237]
    v_pk_fma_f32 v[236:237], v[172:173], v[24:25], v[236:237]
    v_pk_fma_f32 v[236:237], v[180:181], v[16:17], v[236:237]
    v_lshlrev_b32 v2, 16, v120
    v_and_b32 v3, 0xffff0000, v120
    v_pk_mul_f32 v[236:237], v[236:237], v[2:3]
    v_pk_mul_f32 v[238:239], v[158:159], v[42:43]
    v_pk_fma_f32 v[238:239], v[166:167], v[34:35], v[238:239]
    v_pk_fma_f32 v[238:239], v[174:175], v[26:27], v[238:239]
    v_pk_fma_f32 v[238:239], v[182:183], v[18:19], v[238:239]
    v_lshlrev_b32 v2, 16, v121
    v_and_b32 v3, 0xffff0000, v121
    v_pk_mul_f32 v[238:239], v[238:239], v[2:3]
    v_pk_mul_f32 v[240:241], v[160:161], v[44:45]
    v_pk_fma_f32 v[240:241], v[168:169], v[36:37], v[240:241]
    v_pk_fma_f32 v[240:241], v[176:177], v[28:29], v[240:241]
    v_pk_fma_f32 v[240:241], v[184:185], v[20:21], v[240:241]
    v_lshlrev_b32 v2, 16, v122
    v_and_b32 v3, 0xffff0000, v122
    v_pk_mul_f32 v[240:241], v[240:241], v[2:3]
    v_pk_mul_f32 v[242:243], v[162:163], v[46:47]
    v_pk_fma_f32 v[242:243], v[170:171], v[38:39], v[242:243]
    v_pk_fma_f32 v[242:243], v[178:179], v[30:31], v[242:243]
    v_pk_fma_f32 v[242:243], v[186:187], v[22:23], v[242:243]
    v_lshlrev_b32 v2, 16, v123
    v_and_b32 v3, 0xffff0000, v123
    v_pk_mul_f32 v[242:243], v[242:243], v[2:3]
    v_pk_mul_f32 v[244:245], v[148:149], v[40:41]
    v_pk_fma_f32 v[244:245], v[156:157], v[32:33], v[244:245]
    v_pk_fma_f32 v[244:245], v[164:165], v[24:25], v[244:245]
    v_pk_fma_f32 v[244:245], v[172:173], v[16:17], v[244:245]
    v_lshlrev_b32 v2, 16, v116
    v_and_b32 v3, 0xffff0000, v116
    v_pk_mul_f32 v[244:245], v[244:245], v[2:3]
    v_pk_mul_f32 v[246:247], v[150:151], v[42:43]
    v_pk_fma_f32 v[246:247], v[158:159], v[34:35], v[246:247]
    v_pk_fma_f32 v[246:247], v[166:167], v[26:27], v[246:247]
    v_pk_fma_f32 v[246:247], v[174:175], v[18:19], v[246:247]
    v_lshlrev_b32 v2, 16, v117
    v_and_b32 v3, 0xffff0000, v117
    v_pk_mul_f32 v[246:247], v[246:247], v[2:3]
    v_pk_mul_f32 v[248:249], v[152:153], v[44:45]
    v_pk_fma_f32 v[248:249], v[160:161], v[36:37], v[248:249]
    v_pk_fma_f32 v[248:249], v[168:169], v[28:29], v[248:249]
    v_pk_fma_f32 v[248:249], v[176:177], v[20:21], v[248:249]
    v_lshlrev_b32 v2, 16, v118
    v_and_b32 v3, 0xffff0000, v118
    v_pk_mul_f32 v[248:249], v[248:249], v[2:3]
    v_pk_mul_f32 v[250:251], v[154:155], v[46:47]
    v_pk_fma_f32 v[250:251], v[162:163], v[38:39], v[250:251]
    v_pk_fma_f32 v[250:251], v[170:171], v[30:31], v[250:251]
    v_pk_fma_f32 v[250:251], v[178:179], v[22:23], v[250:251]
    v_lshlrev_b32 v2, 16, v119
    v_and_b32 v3, 0xffff0000, v119
    v_pk_mul_f32 v[250:251], v[250:251], v[2:3]
    v_cvt_pk_bf16_f32 v75, v236, v244
    v_cvt_pk_bf16_f32 v79, v237, v245
    v_cvt_pk_bf16_f32 v83, v238, v246
    v_cvt_pk_bf16_f32 v87, v239, v247
    v_cvt_pk_bf16_f32 v91, v240, v248
    v_cvt_pk_bf16_f32 v95, v241, v249
    v_cvt_pk_bf16_f32 v99, v242, v250
    v_cvt_pk_bf16_f32 v103, v243, v251
    s_mov_b32 s62, 10485760
    buffer_store_dwordx4 v[72:75], v9, s[52:55], s62 offen sc0 sc1
    s_add_u32 s62, s62, 4096
    buffer_store_dwordx4 v[76:79], v9, s[52:55], s62 offen sc0 sc1
    s_add_u32 s62, s62, 4096
    buffer_store_dwordx4 v[80:83], v9, s[52:55], s62 offen sc0 sc1
    s_add_u32 s62, s62, 4096
    buffer_store_dwordx4 v[84:87], v9, s[52:55], s62 offen sc0 sc1
    s_add_u32 s62, s62, 4096
    buffer_store_dwordx4 v[88:91], v9, s[52:55], s62 offen sc0 sc1
    s_add_u32 s62, s62, 4096
    buffer_store_dwordx4 v[92:95], v9, s[52:55], s62 offen sc0 sc1
    s_add_u32 s62, s62, 4096
    buffer_store_dwordx4 v[96:99], v9, s[52:55], s62 offen sc0 sc1
    s_add_u32 s62, s62, 4096
    buffer_store_dwordx4 v[100:103], v9, s[52:55], s62 offen sc0 sc1
prep_arriveA:
    s_waitcnt vmcnt(0)
    v_mov_b32 v2, 161544
    v_mov_b32 v3, 1
    s_mov_b64 exec, 1
    ds_add_rtn_u32 v4, v2, v3
    s_mov_b64 exec, -1
    s_waitcnt lgkmcnt(0)
    v_readfirstlane_b32 s62, v4
    s_cmp_lg_u32 s62, 4
    s_cbranch_scc1 prep_post

    v_mov_b32 v2, 0
    v_mov_b32 v3, 1
    s_mov_b64 exec, 1
    buffer_atomic_add v3, v2, s[56:59], 0 offen sc0 sc1
    s_waitcnt vmcnt(0)
    v_readfirstlane_b32 s62, v3
    v_mov_b32 v2, 128
    v_mov_b32 v3, 1
    s_cmp_lg_u32 s62, 63
    s_cbranch_scc1 pa_x
    buffer_store_dword v3, v2, s[56:59], 0 offen sc0 sc1

pa_x:
    s_mov_b64 exec, -1
prep_post:
    s_setprio 0
    s_cmp_lt_u32 s60, 4
    s_cbranch_scc1 p2_gemm
    s_mov_b32 s88, 0
    s_lshl_b32 s90, s2, 2
    s_add_u32 s90, s90, 384
    s_mov_b32 s91, 2
    v_lshlrev_b32 v2, 4, v1
    s_and_b32 s62, s60, 1
    s_lshl_b32 s62, s62, 11
    v_add_u32 v2, s62, v2
    s_lshr_b32 s64, s60, 1
    s_and_b32 s64, s64, 1
    s_add_u32 s64, s64, s90

    s_add_u32 s62, s64, 0
    s_lshl_b32 s63, s62, 12
    s_add_u32 s84, s12, s63
    s_addc_u32 s85, s13, 0
    s_and_b32 s85, s85, 0xffff
    s_mov_b32 s86, 4096
    s_mov_b32 s87, 0x00020000

    buffer_load_dwordx4 v[176:179], v2, s[84:87], 0 offen offset:0
    buffer_load_dwordx4 v[180:183], v2, s[84:87], 0 offen offset:4
    buffer_load_dwordx4 v[184:187], v2, s[84:87], 0 offen offset:8
    buffer_load_dwordx4 v[192:195], v2, s[84:87], 0 offen offset:1024
    buffer_load_dwordx4 v[196:199], v2, s[84:87], 0 offen offset:1028
    buffer_load_dwordx4 v[200:203], v2, s[84:87], 0 offen offset:1032
    s_add_u32 s62, s64, 2
    s_lshl_b32 s63, s62, 12
    s_add_u32 s84, s12, s63
    s_addc_u32 s85, s13, 0
    s_and_b32 s85, s85, 0xffff
    s_mov_b32 s86, 4096
    s_mov_b32 s87, 0x00020000

    buffer_load_dwordx4 v[208:211], v2, s[84:87], 0 offen offset:0
    buffer_load_dwordx4 v[212:215], v2, s[84:87], 0 offen offset:4
    buffer_load_dwordx4 v[216:219], v2, s[84:87], 0 offen offset:8
    buffer_load_dwordx4 v[224:227], v2, s[84:87], 0 offen offset:1024
    buffer_load_dwordx4 v[228:231], v2, s[84:87], 0 offen offset:1028
    buffer_load_dwordx4 v[232:235], v2, s[84:87], 0 offen offset:1032
    s_waitcnt vmcnt(6)
    s_branch p2_conv
prepB_63:
    s_mov_b32 s65, s60
    s_mul_i32 s63, s61, 40960
    s_mul_i32 s62, s65, 640
    s_add_u32 s63, s63, s62
    s_mul_i32 s64, s65, 21504
    v_mov_b32 v7, v1

    v_mul_u32_u24 v2, 49933, v7
    v_lshrrev_b32 v2, 21, v2
    v_mul_u32_u24 v3, 42, v2
    v_sub_u32 v3, v7, v3
    v_min_u32 v3, 39, v3
    v_and_b32 v4, 0x13, v2
    v_and_b32 v5, 4, v2
    v_lshl_or_b32 v4, v5, 1, v4
    v_and_b32 v5, 8, v2
    v_lshrrev_b32 v5, 1, v5
    v_or_b32 v4, v4, v5
    v_mul_u32_u24 v4, 1280, v4
    v_lshl_add_u32 v4, v3, 4, v4
    s_add_u32 m0, s64, 0
    v_add_u32 v7, 64, v7
    buffer_load_dwordx4 v4, s[48:51], s63 offen lds

    v_mul_u32_u24 v2, 49933, v7
    v_lshrrev_b32 v2, 21, v2
    v_mul_u32_u24 v3, 42, v2
    v_sub_u32 v3, v7, v3
    v_min_u32 v3, 39, v3
    v_and_b32 v4, 0x13, v2
    v_and_b32 v5, 4, v2
    v_lshl_or_b32 v4, v5, 1, v4
    v_and_b32 v5, 8, v2
    v_lshrrev_b32 v5, 1, v5
    v_or_b32 v4, v4, v5
    v_mul_u32_u24 v4, 1280, v4
    v_lshl_add_u32 v4, v3, 4, v4
    s_add_u32 m0, s64, 1024
    v_add_u32 v7, 64, v7
    buffer_load_dwordx4 v4, s[48:51], s63 offen lds

    v_mul_u32_u24 v2, 49933, v7
    v_lshrrev_b32 v2, 21, v2
    v_mul_u32_u24 v3, 42, v2
    v_sub_u32 v3, v7, v3
    v_min_u32 v3, 39, v3
    v_and_b32 v4, 0x13, v2
    v_and_b32 v5, 4, v2
    v_lshl_or_b32 v4, v5, 1, v4
    v_and_b32 v5, 8, v2
    v_lshrrev_b32 v5, 1, v5
    v_or_b32 v4, v4, v5
    v_mul_u32_u24 v4, 1280, v4
    v_lshl_add_u32 v4, v3, 4, v4
    s_add_u32 m0, s64, 2048
    v_add_u32 v7, 64, v7
    buffer_load_dwordx4 v4, s[48:51], s63 offen lds

    v_mul_u32_u24 v2, 49933, v7
    v_lshrrev_b32 v2, 21, v2
    v_mul_u32_u24 v3, 42, v2
    v_sub_u32 v3, v7, v3
    v_min_u32 v3, 39, v3
    v_and_b32 v4, 0x13, v2
    v_and_b32 v5, 4, v2
    v_lshl_or_b32 v4, v5, 1, v4
    v_and_b32 v5, 8, v2
    v_lshrrev_b32 v5, 1, v5
    v_or_b32 v4, v4, v5
    v_mul_u32_u24 v4, 1280, v4
    v_lshl_add_u32 v4, v3, 4, v4
    s_add_u32 m0, s64, 3072
    v_add_u32 v7, 64, v7
    buffer_load_dwordx4 v4, s[48:51], s63 offen lds

    v_mul_u32_u24 v2, 49933, v7
    v_lshrrev_b32 v2, 21, v2
    v_mul_u32_u24 v3, 42, v2
    v_sub_u32 v3, v7, v3
    v_min_u32 v3, 39, v3
    v_and_b32 v4, 0x13, v2
    v_and_b32 v5, 4, v2
    v_lshl_or_b32 v4, v5, 1, v4
    v_and_b32 v5, 8, v2
    v_lshrrev_b32 v5, 1, v5
    v_or_b32 v4, v4, v5
    v_mul_u32_u24 v4, 1280, v4
    v_lshl_add_u32 v4, v3, 4, v4
    s_add_u32 m0, s64, 4096
    v_add_u32 v7, 64, v7
    buffer_load_dwordx4 v4, s[48:51], s63 offen lds

    v_mul_u32_u24 v2, 49933, v7
    v_lshrrev_b32 v2, 21, v2
    v_mul_u32_u24 v3, 42, v2
    v_sub_u32 v3, v7, v3
    v_min_u32 v3, 39, v3
    v_and_b32 v4, 0x13, v2
    v_and_b32 v5, 4, v2
    v_lshl_or_b32 v4, v5, 1, v4
    v_and_b32 v5, 8, v2
    v_lshrrev_b32 v5, 1, v5
    v_or_b32 v4, v4, v5
    v_mul_u32_u24 v4, 1280, v4
    v_lshl_add_u32 v4, v3, 4, v4
    s_add_u32 m0, s64, 5120
    v_add_u32 v7, 64, v7
    buffer_load_dwordx4 v4, s[48:51], s63 offen lds

    v_mul_u32_u24 v2, 49933, v7
    v_lshrrev_b32 v2, 21, v2
    v_mul_u32_u24 v3, 42, v2
    v_sub_u32 v3, v7, v3
    v_min_u32 v3, 39, v3
    v_and_b32 v4, 0x13, v2
    v_and_b32 v5, 4, v2
    v_lshl_or_b32 v4, v5, 1, v4
    v_and_b32 v5, 8, v2
    v_lshrrev_b32 v5, 1, v5
    v_or_b32 v4, v4, v5
    v_mul_u32_u24 v4, 1280, v4
    v_lshl_add_u32 v4, v3, 4, v4
    s_add_u32 m0, s64, 6144
    v_add_u32 v7, 64, v7
    buffer_load_dwordx4 v4, s[48:51], s63 offen lds

    v_mul_u32_u24 v2, 49933, v7
    v_lshrrev_b32 v2, 21, v2
    v_mul_u32_u24 v3, 42, v2
    v_sub_u32 v3, v7, v3
    v_min_u32 v3, 39, v3
    v_and_b32 v4, 0x13, v2
    v_and_b32 v5, 4, v2
    v_lshl_or_b32 v4, v5, 1, v4
    v_and_b32 v5, 8, v2
    v_lshrrev_b32 v5, 1, v5
    v_or_b32 v4, v4, v5
    v_mul_u32_u24 v4, 1280, v4
    v_lshl_add_u32 v4, v3, 4, v4
    s_add_u32 m0, s64, 7168
    v_add_u32 v7, 64, v7
    buffer_load_dwordx4 v4, s[48:51], s63 offen lds

    v_mul_u32_u24 v2, 49933, v7
    v_lshrrev_b32 v2, 21, v2
    v_mul_u32_u24 v3, 42, v2
    v_sub_u32 v3, v7, v3
    v_min_u32 v3, 39, v3
    v_and_b32 v4, 0x13, v2
    v_and_b32 v5, 4, v2
    v_lshl_or_b32 v4, v5, 1, v4
    v_and_b32 v5, 8, v2
    v_lshrrev_b32 v5, 1, v5
    v_or_b32 v4, v4, v5
    v_mul_u32_u24 v4, 1280, v4
    v_lshl_add_u32 v4, v3, 4, v4
    s_add_u32 m0, s64, 8192
    v_add_u32 v7, 64, v7
    buffer_load_dwordx4 v4, s[48:51], s63 offen lds

    v_mul_u32_u24 v2, 49933, v7
    v_lshrrev_b32 v2, 21, v2
    v_mul_u32_u24 v3, 42, v2
    v_sub_u32 v3, v7, v3
    v_min_u32 v3, 39, v3
    v_and_b32 v4, 0x13, v2
    v_and_b32 v5, 4, v2
    v_lshl_or_b32 v4, v5, 1, v4
    v_and_b32 v5, 8, v2
    v_lshrrev_b32 v5, 1, v5
    v_or_b32 v4, v4, v5
    v_mul_u32_u24 v4, 1280, v4
    v_lshl_add_u32 v4, v3, 4, v4
    s_add_u32 m0, s64, 9216
    v_add_u32 v7, 64, v7
    buffer_load_dwordx4 v4, s[48:51], s63 offen lds

    v_mul_u32_u24 v2, 49933, v7
    v_lshrrev_b32 v2, 21, v2
    v_mul_u32_u24 v3, 42, v2
    v_sub_u32 v3, v7, v3
    v_min_u32 v3, 39, v3
    v_and_b32 v4, 0x13, v2
    v_and_b32 v5, 4, v2
    v_lshl_or_b32 v4, v5, 1, v4
    v_and_b32 v5, 8, v2
    v_lshrrev_b32 v5, 1, v5
    v_or_b32 v4, v4, v5
    v_mul_u32_u24 v4, 1280, v4
    v_lshl_add_u32 v4, v3, 4, v4
    s_add_u32 m0, s64, 10240
    v_add_u32 v7, 64, v7
    buffer_load_dwordx4 v4, s[48:51], s63 offen lds

    v_mul_u32_u24 v2, 49933, v7
    v_lshrrev_b32 v2, 21, v2
    v_mul_u32_u24 v3, 42, v2
    v_sub_u32 v3, v7, v3
    v_min_u32 v3, 39, v3
    v_and_b32 v4, 0x13, v2
    v_and_b32 v5, 4, v2
    v_lshl_or_b32 v4, v5, 1, v4
    v_and_b32 v5, 8, v2
    v_lshrrev_b32 v5, 1, v5
    v_or_b32 v4, v4, v5
    v_mul_u32_u24 v4, 1280, v4
    v_lshl_add_u32 v4, v3, 4, v4
    s_add_u32 m0, s64, 11264
    v_add_u32 v7, 64, v7
    buffer_load_dwordx4 v4, s[48:51], s63 offen lds

    v_mul_u32_u24 v2, 49933, v7
    v_lshrrev_b32 v2, 21, v2
    v_mul_u32_u24 v3, 42, v2
    v_sub_u32 v3, v7, v3
    v_min_u32 v3, 39, v3
    v_and_b32 v4, 0x13, v2
    v_and_b32 v5, 4, v2
    v_lshl_or_b32 v4, v5, 1, v4
    v_and_b32 v5, 8, v2
    v_lshrrev_b32 v5, 1, v5
    v_or_b32 v4, v4, v5
    v_mul_u32_u24 v4, 1280, v4
    v_lshl_add_u32 v4, v3, 4, v4
    s_add_u32 m0, s64, 12288
    v_add_u32 v7, 64, v7
    buffer_load_dwordx4 v4, s[48:51], s63 offen lds

    v_mul_u32_u24 v2, 49933, v7
    v_lshrrev_b32 v2, 21, v2
    v_mul_u32_u24 v3, 42, v2
    v_sub_u32 v3, v7, v3
    v_min_u32 v3, 39, v3
    v_and_b32 v4, 0x13, v2
    v_and_b32 v5, 4, v2
    v_lshl_or_b32 v4, v5, 1, v4
    v_and_b32 v5, 8, v2
    v_lshrrev_b32 v5, 1, v5
    v_or_b32 v4, v4, v5
    v_mul_u32_u24 v4, 1280, v4
    v_lshl_add_u32 v4, v3, 4, v4
    s_add_u32 m0, s64, 13312
    v_add_u32 v7, 64, v7
    buffer_load_dwordx4 v4, s[48:51], s63 offen lds

    v_mul_u32_u24 v2, 49933, v7
    v_lshrrev_b32 v2, 21, v2
    v_mul_u32_u24 v3, 42, v2
    v_sub_u32 v3, v7, v3
    v_min_u32 v3, 39, v3
    v_and_b32 v4, 0x13, v2
    v_and_b32 v5, 4, v2
    v_lshl_or_b32 v4, v5, 1, v4
    v_and_b32 v5, 8, v2
    v_lshrrev_b32 v5, 1, v5
    v_or_b32 v4, v4, v5
    v_mul_u32_u24 v4, 1280, v4
    v_lshl_add_u32 v4, v3, 4, v4
    s_add_u32 m0, s64, 14336
    v_add_u32 v7, 64, v7
    buffer_load_dwordx4 v4, s[48:51], s63 offen lds

    v_mul_u32_u24 v2, 49933, v7
    v_lshrrev_b32 v2, 21, v2
    v_mul_u32_u24 v3, 42, v2
    v_sub_u32 v3, v7, v3
    v_min_u32 v3, 39, v3
    v_and_b32 v4, 0x13, v2
    v_and_b32 v5, 4, v2
    v_lshl_or_b32 v4, v5, 1, v4
    v_and_b32 v5, 8, v2
    v_lshrrev_b32 v5, 1, v5
    v_or_b32 v4, v4, v5
    v_mul_u32_u24 v4, 1280, v4
    v_lshl_add_u32 v4, v3, 4, v4
    s_add_u32 m0, s64, 15360
    v_add_u32 v7, 64, v7
    buffer_load_dwordx4 v4, s[48:51], s63 offen lds

    v_mul_u32_u24 v2, 49933, v7
    v_lshrrev_b32 v2, 21, v2
    v_mul_u32_u24 v3, 42, v2
    v_sub_u32 v3, v7, v3
    v_min_u32 v3, 39, v3
    v_and_b32 v4, 0x13, v2
    v_and_b32 v5, 4, v2
    v_lshl_or_b32 v4, v5, 1, v4
    v_and_b32 v5, 8, v2
    v_lshrrev_b32 v5, 1, v5
    v_or_b32 v4, v4, v5
    v_mul_u32_u24 v4, 1280, v4
    v_lshl_add_u32 v4, v3, 4, v4
    s_add_u32 m0, s64, 16384
    v_add_u32 v7, 64, v7
    buffer_load_dwordx4 v4, s[48:51], s63 offen lds

    v_mul_u32_u24 v2, 49933, v7
    v_lshrrev_b32 v2, 21, v2
    v_mul_u32_u24 v3, 42, v2
    v_sub_u32 v3, v7, v3
    v_min_u32 v3, 39, v3
    v_and_b32 v4, 0x13, v2
    v_and_b32 v5, 4, v2
    v_lshl_or_b32 v4, v5, 1, v4
    v_and_b32 v5, 8, v2
    v_lshrrev_b32 v5, 1, v5
    v_or_b32 v4, v4, v5
    v_mul_u32_u24 v4, 1280, v4
    v_lshl_add_u32 v4, v3, 4, v4
    s_add_u32 m0, s64, 17408
    v_add_u32 v7, 64, v7
    buffer_load_dwordx4 v4, s[48:51], s63 offen lds

    v_mul_u32_u24 v2, 49933, v7
    v_lshrrev_b32 v2, 21, v2
    v_mul_u32_u24 v3, 42, v2
    v_sub_u32 v3, v7, v3
    v_min_u32 v3, 39, v3
    v_and_b32 v4, 0x13, v2
    v_and_b32 v5, 4, v2
    v_lshl_or_b32 v4, v5, 1, v4
    v_and_b32 v5, 8, v2
    v_lshrrev_b32 v5, 1, v5
    v_or_b32 v4, v4, v5
    v_mul_u32_u24 v4, 1280, v4
    v_lshl_add_u32 v4, v3, 4, v4
    s_add_u32 m0, s64, 18432
    v_add_u32 v7, 64, v7
    buffer_load_dwordx4 v4, s[48:51], s63 offen lds

    v_mul_u32_u24 v2, 49933, v7
    v_lshrrev_b32 v2, 21, v2
    v_mul_u32_u24 v3, 42, v2
    v_sub_u32 v3, v7, v3
    v_min_u32 v3, 39, v3
    v_and_b32 v4, 0x13, v2
    v_and_b32 v5, 4, v2
    v_lshl_or_b32 v4, v5, 1, v4
    v_and_b32 v5, 8, v2
    v_lshrrev_b32 v5, 1, v5
    v_or_b32 v4, v4, v5
    v_mul_u32_u24 v4, 1280, v4
    v_lshl_add_u32 v4, v3, 4, v4
    s_add_u32 m0, s64, 19456
    v_add_u32 v7, 64, v7
    buffer_load_dwordx4 v4, s[48:51], s63 offen lds

    v_mul_u32_u24 v2, 49933, v7
    v_lshrrev_b32 v2, 21, v2
    v_mul_u32_u24 v3, 42, v2
    v_sub_u32 v3, v7, v3
    v_min_u32 v3, 39, v3
    v_and_b32 v4, 0x13, v2
    v_and_b32 v5, 4, v2
    v_lshl_or_b32 v4, v5, 1, v4
    v_and_b32 v5, 8, v2
    v_lshrrev_b32 v5, 1, v5
    v_or_b32 v4, v4, v5
    v_mul_u32_u24 v4, 1280, v4
    v_lshl_add_u32 v4, v3, 4, v4
    s_add_u32 m0, s64, 20480
    v_add_u32 v7, 64, v7
    buffer_load_dwordx4 v4, s[48:51], s63 offen lds

    s_barrier
    v_lshrrev_b32 v2, 2, v1
    v_and_b32 v2, 3, v2
    v_lshrrev_b32 v3, 4, v1
    v_and_b32 v4, 1, v3
    v_lshl_add_u32 v2, v4, 2, v2
    v_lshrrev_b32 v3, 1, v3
    v_lshl_add_u32 v2, v3, 4, v2
    v_mul_u32_u24 v2, 672, v2
    v_and_b32 v3, 3, v1
    v_lshl_add_u32 v2, v3, 3, v2
    v_add_u32 v2, s64, v2
    v_lshlrev_b32 v3, 4, v1
    v_add_u32 v4, 4096, v3
    s_mul_i32 s63, s65, 216
    s_add_u32 s63, s63, s61
    s_mul_i32 s63, s63, 5120
    s_add_u32 s63, s63, 7340032
    s_waitcnt vmcnt(0)

    ds_read_b64_tr_b16 v[16:17], v2 offset:0
    ds_read_b64_tr_b16 v[18:19], v2 offset:5376
    ds_read_b64_tr_b16 v[20:21], v2 offset:32
    ds_read_b64_tr_b16 v[22:23], v2 offset:5408
    ds_read_b64_tr_b16 v[24:25], v2 offset:64
    ds_read_b64_tr_b16 v[26:27], v2 offset:5440
    ds_read_b64_tr_b16 v[28:29], v2 offset:96
    ds_read_b64_tr_b16 v[30:31], v2 offset:5472
    ds_read_b64_tr_b16 v[32:33], v2 offset:128
    ds_read_b64_tr_b16 v[34:35], v2 offset:5504
    ds_read_b64_tr_b16 v[36:37], v2 offset:160
    ds_read_b64_tr_b16 v[38:39], v2 offset:5536
    ds_read_b64_tr_b16 v[40:41], v2 offset:192
    ds_read_b64_tr_b16 v[42:43], v2 offset:5568
    ds_read_b64_tr_b16 v[44:45], v2 offset:224
    ds_read_b64_tr_b16 v[46:47], v2 offset:5600
    ds_read_b64_tr_b16 v[48:49], v2 offset:256
    ds_read_b64_tr_b16 v[50:51], v2 offset:5632
    ds_read_b64_tr_b16 v[52:53], v2 offset:288
    ds_read_b64_tr_b16 v[54:55], v2 offset:5664
    ds_read_b64_tr_b16 v[56:57], v2 offset:320
    ds_read_b64_tr_b16 v[58:59], v2 offset:5696
    ds_read_b64_tr_b16 v[60:61], v2 offset:352
    ds_read_b64_tr_b16 v[62:63], v2 offset:5728
    ds_read_b64_tr_b16 v[64:65], v2 offset:384
    ds_read_b64_tr_b16 v[66:67], v2 offset:5760
    ds_read_b64_tr_b16 v[68:69], v2 offset:416
    ds_read_b64_tr_b16 v[70:71], v2 offset:5792
    ds_read_b64_tr_b16 v[72:73], v2 offset:448
    ds_read_b64_tr_b16 v[74:75], v2 offset:5824
    ds_read_b64_tr_b16 v[76:77], v2 offset:480
    ds_read_b64_tr_b16 v[78:79], v2 offset:5856
    ds_read_b64_tr_b16 v[80:81], v2 offset:512
    ds_read_b64_tr_b16 v[82:83], v2 offset:5888
    ds_read_b64_tr_b16 v[84:85], v2 offset:544
    ds_read_b64_tr_b16 v[86:87], v2 offset:5920
    ds_read_b64_tr_b16 v[88:89], v2 offset:576
    ds_read_b64_tr_b16 v[90:91], v2 offset:5952
    ds_read_b64_tr_b16 v[92:93], v2 offset:608
    ds_read_b64_tr_b16 v[94:95], v2 offset:5984
    s_waitcnt lgkmcnt(0)
    buffer_store_dwordx4 v[16:19], v3, s[52:55], s63 offen offset:0 sc0 sc1
    buffer_store_dwordx4 v[20:23], v3, s[52:55], s63 offen offset:1024 sc0 sc1
    buffer_store_dwordx4 v[24:27], v3, s[52:55], s63 offen offset:2048 sc0 sc1
    buffer_store_dwordx4 v[28:31], v3, s[52:55], s63 offen offset:3072 sc0 sc1
    buffer_store_dwordx4 v[32:35], v4, s[52:55], s63 offen sc0 sc1
    s_add_u32 s63, s63, 276480
    buffer_store_dwordx4 v[36:39], v3, s[52:55], s63 offen offset:0 sc0 sc1
    buffer_store_dwordx4 v[40:43], v3, s[52:55], s63 offen offset:1024 sc0 sc1
    buffer_store_dwordx4 v[44:47], v3, s[52:55], s63 offen offset:2048 sc0 sc1
    buffer_store_dwordx4 v[48:51], v3, s[52:55], s63 offen offset:3072 sc0 sc1
    buffer_store_dwordx4 v[52:55], v4, s[52:55], s63 offen sc0 sc1
    s_add_u32 s63, s63, 276480
    buffer_store_dwordx4 v[56:59], v3, s[52:55], s63 offen offset:0 sc0 sc1
    buffer_store_dwordx4 v[60:63], v3, s[52:55], s63 offen offset:1024 sc0 sc1
    buffer_store_dwordx4 v[64:67], v3, s[52:55], s63 offen offset:2048 sc0 sc1
    buffer_store_dwordx4 v[68:71], v3, s[52:55], s63 offen offset:3072 sc0 sc1
    buffer_store_dwordx4 v[72:75], v4, s[52:55], s63 offen sc0 sc1
    s_add_u32 s63, s63, 276480
    buffer_store_dwordx4 v[76:79], v3, s[52:55], s63 offen offset:0 sc0 sc1
    buffer_store_dwordx4 v[80:83], v3, s[52:55], s63 offen offset:1024 sc0 sc1
    buffer_store_dwordx4 v[84:87], v3, s[52:55], s63 offen offset:2048 sc0 sc1
    buffer_store_dwordx4 v[88:91], v3, s[52:55], s63 offen offset:3072 sc0 sc1
    buffer_store_dwordx4 v[92:95], v4, s[52:55], s63 offen sc0 sc1
    s_add_u32 s63, s63, 276480
    s_waitcnt vmcnt(0)
    v_mov_b32 v2, 161548
    v_mov_b32 v3, 1
    s_mov_b64 exec, 1
    ds_add_rtn_u32 v4, v2, v3
    s_mov_b64 exec, -1
    s_waitcnt lgkmcnt(0)
    v_readfirstlane_b32 s62, v4
    s_cmp_lg_u32 s62, 1
    s_cbranch_scc1 prep_post

    v_mov_b32 v2, 161564
    ds_read_b32 v3, v2
    s_waitcnt lgkmcnt(0)
    v_readfirstlane_b32 s62, v3
    s_cmp_lg_u32 s62, 0
    s_cbranch_scc1 zok_65

    v_mov_b32 v2, 192
pg_66:
    buffer_load_dword v3, v2, s[56:59], 0 offen sc1
    s_waitcnt vmcnt(0)
    v_readfirstlane_b32 s62, v3
    s_cmp_lg_u32 s62, 0
    s_cbranch_scc1 pgd_67
    s_sleep 32
    s_add_u32 s96, s96, 1
    s_cmp_lt_u32 s96, 0x400000
    s_cbranch_scc1 pg_66

pgd_67:
    v_mov_b32 v2, 161564
    ds_write_b32 v2, v3

zok_65:
    v_mov_b32 v2, 16883200
    v_mov_b32 v3, 1
    s_mov_b64 exec, 1
    buffer_atomic_add v3, v2, s[52:55], 0 offen sc0 sc1
    s_waitcnt vmcnt(0)
    v_readfirstlane_b32 s62, v3
    s_mov_b64 exec, -1
    s_cmp_lg_u32 s62, 63
    s_cbranch_scc1 prep_post
    v_lshlrev_b32 v2, 8, v1
    v_add_u32 v2, 16883712, v2
    v_mov_b32 v3, 1
    s_mov_b64 exec, 0xffff
    buffer_store_dword v3, v2, s[52:55], 0 offen sc0 sc1
    s_mov_b64 exec, -1
    s_branch prep_post

prepC_64:
    v_mov_b32 v3, 0
    v_lshlrev_b32 v4, 2, v1
    v_add_u32 v4, 161536, v4
    ds_write_b32 v4, v3
    s_cmp_lg_u32 s2, 0
    s_cbranch_scc1 prep_nz
    v_lshlrev_b32 v4, 8, v1
    v_add_u32 v4, 16875520, v4
    buffer_store_dword v3, v4, s[52:55], 0 offen sc0 sc1
    buffer_store_dword v3, v4, s[52:55], 0 offen offset:128 sc0 sc1
    v_mov_b32 v4, 192
    v_mov_b32 v3, 1
    s_waitcnt vmcnt(0)
    s_mov_b64 exec, 1
    buffer_store_dword v3, v4, s[56:59], 0 offen sc0 sc1
    s_mov_b64 exec, -1

prep_nz:
    s_waitcnt lgkmcnt(0)
    s_barrier
    s_waitcnt vmcnt(0)

    s_branch prep_post

k1_exit:
    s_endpgm
.section .rodata,"a"
.p2align 6
.amdhsa_kernel recurrent_scan__ssm_conv_h3__dense_activation_silu__prompt_kernel
  .amdhsa_next_free_vgpr 256
  .amdhsa_next_free_sgpr 102
  .amdhsa_accum_offset 256
  .amdhsa_group_segment_fixed_size 0
  .amdhsa_kernarg_size 96
  .amdhsa_user_sgpr_count 2
  .amdhsa_user_sgpr_kernarg_segment_ptr 1
  .amdhsa_system_sgpr_workgroup_id_x 1
.end_amdhsa_kernel
```
